```python
import torch

def _softmax(x, axis=-1):
    return torch.softmax(x, dim=axis)
def _gelu(x):
    return torch.nn.functional.gelu(x, approximate="tanh")
def _silu(x):
    return torch.nn.functional.silu(x)
def _sigmoid(x):
    return torch.sigmoid(x)
def _layernorm(x, axis=-1, eps=1e-5):
    m = x.mean(dim=axis, keepdim=True)
    v = x.var(dim=axis, keepdim=True, unbiased=False)
    return (x - m) / torch.sqrt(v + eps)
def _scatter_add(tgt, idx, src, axis=0):
    return tgt.clone().index_add_(axis, idx, src)
def _segment_sum(src, seg, n):
    out = torch.zeros((n,) + src.shape[1:], dtype=src.dtype)
    return out.index_add_(0, seg, src)
def _pad(x, pw):
    flat = tuple(v for pair in reversed(pw) for v in pair)
    return torch.nn.functional.pad(x, flat)

kernel_name = 'sequential_preLN__linear_attn_block__dense_activation_silu__prompt'

def setup_inputs():

    _w = (lambda a: (lambda t: t.to(torch.bfloat16) if t.is_floating_point() else t)(torch.as_tensor(a)))
    def _A_setup():
        B, S, D = 1, 2048, 640
        return {
            "x": _w((lambda *s: torch.randn(*s, dtype=torch.bfloat16) * 0.05)(B, S, D)),
            "wqkv": _w((lambda *s: torch.randn(*s, dtype=torch.bfloat16) * 0.05)(D, 3 * D)),
            "wo": _w((lambda *s: torch.randn(*s, dtype=torch.bfloat16) * 0.05)(D, D)),
        }
    _A_in = _A_setup()

    def _B_setup():
        B, S, D, F = 1, 2048, 640, 1728
        return {
            "x": _w((lambda *s: torch.randn(*s, dtype=torch.bfloat16) * 0.05)(B, S, D)),
            "w1": _w((lambda *s: torch.randn(*s, dtype=torch.bfloat16) * 0.8)(D, F) * (D ** -0.5)),
            "w2": _w((lambda *s: torch.randn(*s, dtype=torch.bfloat16) * 0.1)(F, D) * (F ** -0.5)),
        }
    _B_in = _B_setup()

    return {
        "A_x": _A_in["x"],
        "A_wqkv": _A_in["wqkv"],
        "A_wo": _A_in["wo"],
        "B_x": _B_in["x"],
        "B_w1": _B_in["w1"],
        "B_w2": _B_in["w2"],
    }

def reference(A_x, A_wqkv, A_wo, B_x, B_w1, B_w2):
    def _A_ref(x, wqkv, wo):
        B, S, D = x.shape
        H = 32; Dh = D // H
        qkv = (lambda x, *d: x.permute(*d))((x @ wqkv).reshape(B, S, 3, H, Dh), 2, 0, 3, 1, 4)
        q, k, v = qkv[0], qkv[1], qkv[2]
        phi = lambda t: torch.where(t > 0, t + 1, torch.exp(t)) + 1e-6
        pq, pk = phi(q), phi(k)
        kv = torch.einsum("bhsd,bhse->bhde", pk, v)
        z = torch.einsum("bhsd->bhd", pk)
        num = torch.einsum("bhqd,bhde->bhqe", pq, kv)
        den = torch.einsum("bhqd,bhd->bhq", pq, z)[..., None] + 1e-6
        o = num / den
        return (lambda x, *d: x.permute(*d))(o, 0, 2, 1, 3).reshape(B, S, D) @ wo

    def _B_ref(x, w1, w2):
        h = torch.einsum("bsd,df->bsf", x, w1)
        h = _silu(h)
        out = torch.einsum("bsf,fd->bsd", h, w2)
        return out

    x = A_x
    h = x + _A_ref(_layernorm(x, axis=-1), A_wqkv, A_wo)
    h2 = h + _B_ref(_layernorm(h, axis=-1), B_w1, B_w2)
    return h2
```

```asm
; @launch kernel=k1_kernel grid=(256,1,1) block=(512,1,1) lds=163840
; @launch kernel=k2_kernel grid=(256,1,1) block=(256,1,1) lds=81920
; @launch kernel=k3_kernel grid=(256,1,1) block=(512,1,1) lds=143360
; @launch kernel=k4_kernel grid=(256,1,1) block=(256,1,1) lds=81920
.amdgcn_target "amdgcn-amd-amdhsa--gfx950"
.text
.globl k1_kernel
.p2align 8
.type k1_kernel,@function
k1_kernel:
    s_cmp_ge_u32 s2, 256
    s_cbranch_scc1 k1_kernel_end
    s_cmp_ge_u32 s2, 16
    s_cbranch_scc1 pcq_3
    s_getpc_b64 s[94:95]
pc_1:
    s_add_u32 s94, s94, (k1_kernel-pc_1)&0xffffffff
    s_addc_u32 s95, s95, ((k1_kernel-pc_1)>>32)&0xffffffff
    v_lshlrev_b32 v250, 7, v0
    s_mov_b32 s96, k4_kernel_end-k1_kernel
    v_cmp_gt_u32 vcc, s96, v250
    s_and_saveexec_b64 s[98:99], vcc
    s_cbranch_execz pcs_2
    global_load_dword v251, v250, s[94:95] offset:0
pcs_2:
    s_mov_b64 exec, s[98:99]
pcq_3:
    s_load_dwordx4 s[4:7], s[0:1], 0
    s_load_dwordx2 s[8:9], s[0:1], 56
    s_load_dwordx2 s[10:11], s[0:1], 64
    s_load_dwordx2 s[66:67], s[0:1], 16
    s_load_dwordx4 s[80:83], s[0:1], 32
    v_and_b32 v1, 63, v0
    v_lshrrev_b32 v6, 6, v0
    s_and_b32 s15, s2, 7
    s_lshr_b32 s13, s2, 3
    v_readfirstlane_b32 s14, v6
    s_lshr_b32 s12, s13, 3
    s_lshr_b32 s16, s15, 1
    s_lshl_b32 s16, s16, 2
    s_add_u32 s12, s12, s16
    s_and_b32 s13, s13, 7
    s_and_b32 s15, s15, 1
    s_lshl_b32 s15, s15, 3
    s_add_u32 s13, s13, s15
    v_lshrrev_b32 v6, 3, v1
    s_lshl_b32 s15, s14, 4
    v_add_u32 v6, s15, v6
    s_movk_i32 s16, 1280
    v_mul_lo_u32 v6, v6, s16
    v_and_b32 v7, 7, v1
    v_lshrrev_b32 v8, 4, v1
    v_xor_b32 v7, v7, v8
    v_lshlrev_b32 v9, 4, v7
    v_add_u32 v2, v6, v9
    v_xor_b32 v9, 64, v9
    v_add_u32 v3, v6, v9
    s_lshl_b32 s15, s14, 3
    v_add_u32 v7, s15, v8
    s_movk_i32 s16, 3840
    v_mul_lo_u32 v7, v7, s16
    s_and_b32 s15, s14, 1
    s_lshl_b32 s15, s15, 3
    v_lshlrev_b32 v6, 1, v8
    v_add_u32 v6, s15, v6
    v_and_b32 v8, 15, v1
    v_xor_b32 v8, v8, v6
    v_lshlrev_b32 v9, 4, v8
    v_add_u32 v6, 1184, v9
    v_cmp_lt_u32 vcc, 5, v8
    v_cmp_lt_u32 s[42:43], 11, v8
    v_cmp_eq_u32 s[44:45], 11, v8
    v_cndmask_b32 v4, v9, v6, vcc
    v_add_u32 v6, 2368, v9
    v_cndmask_b32 v4, v4, v6, s[42:43]
    v_mov_b32 v6, 2624
    v_cndmask_b32 v4, v4, v6, s[44:45]
    v_cmp_ne_u32 s[40:41], 5, v8
    s_mul_i32 s15, s13, 80
    v_add3_u32 v4, v4, v7, s15
    s_mov_b32 s48, 0
    s_mov_b32 s49, 0
    s_lshl_b32 s56, s14, 11
    s_mov_b32 s36, s56
    s_add_u32 s39, s56, 16384
    s_waitcnt lgkmcnt(0)
    s_mul_i32 s15, s12, 163840
    s_add_u32 s16, s4, s15
    s_addc_u32 s17, s5, 0
    s_and_b32 s17, s17, 0xffff
    s_mov_b32 s18, 0x28000
    s_mov_b32 s19, 0x00020000
    s_mov_b32 s20, s6
    s_and_b32 s21, s7, 0xffff
    s_mov_b32 s22, 0x258000
    s_mov_b32 s23, 0x00020000
    s_lshr_b32 s50, s2, 3
    s_lshl_b32 s50, s50, 3
    s_add_u32 s50, s50, s14
    s_cmp_ge_u32 s50, 150
    s_cbranch_scc1 k1_kernel_pfx
    s_lshl_b32 s51, s50, 6
    v_add_u32 v6, s51, v1
    s_mov_b32 s51, 0x11111112
    v_mul_hi_u32 v7, v6, s51
    v_mul_u32_u24 v8, 15, v7
    v_sub_u32 v8, v6, v8
    v_mul_u32_u24 v9, 13, v8
    v_lshrrev_b32 v9, 6, v9
    v_mul_u32_u24 v7, 3840, v7
    v_mul_u32_u24 v9, 640, v9
    v_lshl_add_u32 v7, v8, 7, v7
    s_and_b32 s51, s2, 1
    s_mul_i32 s51, s51, 640
    v_add3_u32 v7, v7, v9, s51
    buffer_load_dword v249, v7, s[20:23], 0 offen
    s_branch k1_kernel_pfd
k1_kernel_pfx:
    s_cmp_ge_u32 s50, 230
    s_cbranch_scc1 k1_kernel_pfd
    s_sub_u32 s51, s50, 150
    s_lshl_b32 s51, s51, 6
    v_add_u32 v6, s51, v1
    v_mul_u32_u24 v7, 6554, v6
    v_lshrrev_b32 v7, 16, v7
    v_mul_u32_u24 v8, 10, v7
    v_sub_u32 v8, v6, v8
    v_mul_u32_u24 v7, 1280, v7
    v_lshl_add_u32 v7, v8, 7, v7
    s_bfe_u32 s51, s2, 0x20001
    s_mul_i32 s51, s51, 655360
    v_add_u32 v7, s51, v7
    s_mov_b32 s84, s4
    s_and_b32 s85, s5, 0xffff
    s_mov_b32 s86, 0x280000
    s_mov_b32 s87, 0x00020000
    buffer_load_dword v249, v7, s[84:87], 0 offen
k1_kernel_pfd:
    s_mov_b32 m0, s36
    s_lshl_b32 s50, s48, 7
    buffer_load_dwordx4 v2, s[16:19], s50 offen lds
    s_add_u32 s50, s50, 9216
    buffer_load_dwordx4 v3, s[16:19], s50 offen offset:1024 lds
    s_add_u32 s36, s36, 32768
    s_and_b32 s36, s36, 131071
    s_add_u32 s48, s48, 1
    s_cmp_eq_u32 s48, 10
    s_cselect_b32 s48, 0, s48
    s_mov_b32 m0, s39
    s_mul_i32 s51, s49, 245760
    s_mov_b64 exec, s[40:41]
    buffer_load_dwordx4 v4, s[20:23], s51 offen lds
    s_mov_b64 exec, -1
    s_add_u32 s51, s51, 14336
    s_mov_b64 exec, s[40:41]
    buffer_load_dwordx4 v4, s[20:23], s51 offen offset:1024 lds
    s_mov_b64 exec, -1
    s_add_u32 s39, s39, 32768
    s_and_b32 s39, s39, 131071
    s_add_u32 s49, s49, 1
    s_cmp_eq_u32 s49, 10
    s_cselect_b32 s49, 0, s49
    s_mov_b32 m0, s36
    s_lshl_b32 s50, s48, 7
    buffer_load_dwordx4 v2, s[16:19], s50 offen lds
    s_add_u32 s50, s50, 9216
    buffer_load_dwordx4 v3, s[16:19], s50 offen offset:1024 lds
    s_add_u32 s36, s36, 32768
    s_and_b32 s36, s36, 131071
    s_add_u32 s48, s48, 1
    s_cmp_eq_u32 s48, 10
    s_cselect_b32 s48, 0, s48
    s_mov_b32 m0, s39
    s_mul_i32 s51, s49, 245760
    s_mov_b64 exec, s[40:41]
    buffer_load_dwordx4 v4, s[20:23], s51 offen lds
    s_mov_b64 exec, -1
    s_add_u32 s51, s51, 14336
    s_mov_b64 exec, s[40:41]
    buffer_load_dwordx4 v4, s[20:23], s51 offen offset:1024 lds
    s_mov_b64 exec, -1
    s_add_u32 s39, s39, 32768
    s_and_b32 s39, s39, 131071
    s_add_u32 s49, s49, 1
    s_cmp_eq_u32 s49, 10
    s_cselect_b32 s49, 0, s49
    s_mov_b32 m0, s36
    s_lshl_b32 s50, s48, 7
    buffer_load_dwordx4 v2, s[16:19], s50 offen lds
    s_add_u32 s50, s50, 9216
    buffer_load_dwordx4 v3, s[16:19], s50 offen offset:1024 lds
    s_add_u32 s36, s36, 32768
    s_and_b32 s36, s36, 131071
    s_add_u32 s48, s48, 1
    s_cmp_eq_u32 s48, 10
    s_cselect_b32 s48, 0, s48
    s_mov_b32 m0, s39
    s_mul_i32 s51, s49, 245760
    s_mov_b64 exec, s[40:41]
    buffer_load_dwordx4 v4, s[20:23], s51 offen lds
    s_mov_b64 exec, -1
    s_add_u32 s51, s51, 14336
    s_mov_b64 exec, s[40:41]
    buffer_load_dwordx4 v4, s[20:23], s51 offen offset:1024 lds
    s_mov_b64 exec, -1
    s_add_u32 s39, s39, 32768
    s_and_b32 s39, s39, 131071
    s_add_u32 s49, s49, 1
    s_cmp_eq_u32 s49, 10
    s_cselect_b32 s49, 0, s49
    s_mov_b32 m0, s36
    s_lshl_b32 s50, s48, 7
    buffer_load_dwordx4 v2, s[16:19], s50 offen lds
    s_add_u32 s50, s50, 9216
    buffer_load_dwordx4 v3, s[16:19], s50 offen offset:1024 lds
    s_add_u32 s36, s36, 32768
    s_and_b32 s36, s36, 131071
    s_add_u32 s48, s48, 1
    s_cmp_eq_u32 s48, 10
    s_cselect_b32 s48, 0, s48
    v_mov_b32 v116, 0
    v_mov_b32 v117, 0
    v_mov_b32 v118, 0
    v_mov_b32 v119, 0
    v_mov_b32 v120, 0
    v_mov_b32 v121, 0
    v_mov_b32 v122, 0
    v_mov_b32 v123, 0
    v_mov_b32 v124, 0
    v_mov_b32 v125, 0
    v_mov_b32 v126, 0
    v_mov_b32 v127, 0
    v_mov_b32 v128, 0
    v_mov_b32 v129, 0
    v_mov_b32 v130, 0
    v_mov_b32 v131, 0
    v_mov_b32 v132, 0
    v_mov_b32 v133, 0
    v_mov_b32 v134, 0
    v_mov_b32 v135, 0
    v_mov_b32 v136, 0
    v_mov_b32 v137, 0
    v_mov_b32 v138, 0
    v_mov_b32 v139, 0
    v_mov_b32 v140, 0
    v_mov_b32 v141, 0
    v_mov_b32 v142, 0
    v_mov_b32 v143, 0
    v_mov_b32 v144, 0
    v_mov_b32 v145, 0
    v_mov_b32 v146, 0
    v_mov_b32 v147, 0
    v_mov_b32 v148, 0
    v_mov_b32 v149, 0
    v_mov_b32 v150, 0
    v_mov_b32 v151, 0
    v_mov_b32 v152, 0
    v_mov_b32 v153, 0
    v_mov_b32 v154, 0
    v_mov_b32 v155, 0
    v_mov_b32 v156, 0
    v_mov_b32 v157, 0
    v_mov_b32 v158, 0
    v_mov_b32 v159, 0
    v_mov_b32 v160, 0
    v_mov_b32 v161, 0
    v_mov_b32 v162, 0
    v_mov_b32 v163, 0
    v_mov_b32 v164, 0
    v_mov_b32 v165, 0
    v_mov_b32 v166, 0
    v_mov_b32 v167, 0
    v_mov_b32 v168, 0
    v_mov_b32 v169, 0
    v_mov_b32 v170, 0
    v_mov_b32 v171, 0
    v_mov_b32 v172, 0
    v_mov_b32 v173, 0
    v_mov_b32 v174, 0
    v_mov_b32 v175, 0
    v_and_b32 v6, 15, v1
    v_lshrrev_b32 v7, 4, v1
    v_lshrrev_b32 v8, 1, v6
    v_xor_b32 v8, v8, v7
    v_lshlrev_b32 v8, 4, v8
    v_lshl_add_u32 v8, v6, 7, v8
    s_and_b32 s59, s14, 3
    s_lshr_b32 s58, s14, 2
    s_lshl_b32 s15, s59, 12
    v_add_u32 v10, s15, v8
    v_xor_b32 v11, 64, v10
    v_bfe_u32 v6, v1, 2, 2
    v_lshl_add_u32 v8, v7, 3, v6
    v_lshlrev_b32 v8, 8, v8
    v_add_u32 v8, 16384, v8
    v_and_b32 v9, 1, v7
    v_lshl_add_u32 v9, v9, 2, v6
    v_lshlrev_b32 v9, 2, v9
    v_and_b32 v6, 3, v1
    v_lshlrev_b32 v6, 3, v6
    s_mov_b32 s15, 0x3020100
    s_cmp_eq_u32 s58, 0
    s_cselect_b32 s15, s15, 0xf0e0d0c
    v_mov_b32 v7, s15
    v_lshrrev_b32 v7, v6, v7
    v_and_b32 v7, 0xff, v7
    v_xor_b32 v7, v7, v9
    v_lshl_add_u32 v14, v7, 3, v8
    s_mov_b32 s15, 0x8070605
    s_cmp_eq_u32 s58, 0
    s_cselect_b32 s15, s15, 0x13121110
    v_mov_b32 v7, s15
    v_lshrrev_b32 v7, v6, v7
    v_and_b32 v7, 0xff, v7
    v_xor_b32 v7, v7, v9
    v_lshl_add_u32 v15, v7, 3, v8
    s_mov_b32 s15, 0xb0a0904
    s_cmp_eq_u32 s58, 0
    s_cselect_b32 s15, s15, 0x17161514
    v_mov_b32 v7, s15
    v_lshrrev_b32 v7, v6, v7
    v_and_b32 v7, 0xff, v7
    v_xor_b32 v7, v7, v9
    v_lshl_add_u32 v16, v7, 3, v8
    s_mov_b32 s15, 0xb0a0904
    s_cmp_eq_u32 s58, 0
    s_cselect_b32 s15, s15, 0x1b1a1918
    v_mov_b32 v7, s15
    v_lshrrev_b32 v7, v6, v7
    v_and_b32 v7, 0xff, v7
    v_xor_b32 v7, v7, v9
    v_lshl_add_u32 v17, v7, 3, v8
    s_mov_b32 s15, 0xb0a0904
    s_cmp_eq_u32 s58, 0
    s_cselect_b32 s15, s15, 0x1f1e1d1c
    v_mov_b32 v7, s15
    v_lshrrev_b32 v7, v6, v7
    v_and_b32 v7, 0xff, v7
    v_xor_b32 v7, v7, v9
    v_lshl_add_u32 v18, v7, 3, v8
    v_mov_b32 v32, 0x3f803f80
    v_mov_b32 v33, 0x3f803f80
    v_mov_b32 v34, 0x3f803f80
    v_mov_b32 v35, 0x3f803f80
    s_cmp_ge_u32 s14, 4
    s_cbranch_scc1 k1_pp_4
    v_and_b32 v6, 3, v1
    v_bfe_u32 v7, v1, 3, 1
    v_lshl_add_u32 v6, v7, 2, v6
    v_lshlrev_b32 v6, 1, v6
    v_xor_b32 v6, 5, v6
    v_lshlrev_b32 v6, 4, v6
    v_lshl_add_u32 v6, v1, 8, v6
    s_lshl_b32 s15, s14, 15
    s_add_u32 s15, s15, 16384
    v_add_u32 v6, s15, v6
    v_mov_b32 v180, 0x3f80
    v_mov_b32 v181, 0
    v_mov_b32 v182, 0
    v_mov_b32 v183, 0
    ds_write_b128 v6, v[180:183]
k1_pp_4:
    s_lshr_b32 s60, s59, 1
    s_and_b32 s61, s59, 1
    s_mov_b32 s37, 0
    v_add_u32 v12, s37, v10
    v_add_u32 v13, s37, v11
    v_add_u32 v22, s37, v14
    v_add_u32 v23, s37, v15
    v_add_u32 v24, s37, v16
    v_add_u32 v25, s37, v17
    v_add_u32 v26, s37, v18
    s_waitcnt vmcnt(10) lgkmcnt(0)
    s_barrier
    s_mov_b32 s38, 0
    s_cmp_lg_u32 s58, 0
    s_cbranch_scc1 k1_kernel_r1
    ds_read_b128 v[36:39], v12 offset:0
    ds_read_b128 v[40:43], v12 offset:2048
    ds_read_b64_tr_b16 v[52:53], v22 offset:0
    ds_read_b64_tr_b16 v[54:55], v22 offset:1024
    ds_read_b64_tr_b16 v[56:57], v23 offset:0
    ds_read_b64_tr_b16 v[58:59], v23 offset:1024
    ds_read_b64_tr_b16 v[60:61], v24 offset:0
    ds_read_b64_tr_b16 v[62:63], v24 offset:1024
    s_waitcnt lgkmcnt(0)
k1_kernel_loop0:
    v_mfma_f32_16x16x32_bf16 v[116:119], v[52:55], v[36:39], v[116:119]
    ds_read_b128 v[44:47], v13 offset:0
    ds_read_b128 v[48:51], v13 offset:2048
    v_mfma_f32_16x16x32_bf16 v[136:139], v[52:55], v[40:43], v[136:139]
    ds_read_b64_tr_b16 v[72:73], v22 offset:8192
    ds_read_b64_tr_b16 v[74:75], v22 offset:9216
    v_mfma_f32_16x16x32_bf16 v[120:123], v[56:59], v[36:39], v[120:123]
    ds_read_b64_tr_b16 v[76:77], v23 offset:8192
    ds_read_b64_tr_b16 v[78:79], v23 offset:9216
    s_cmp_ge_u32 s38, 7
    s_cbranch_scc1 k1g_5
    s_mov_b32 m0, s39
    s_mul_i32 s51, s49, 245760
    s_mov_b64 exec, s[40:41]
    buffer_load_dwordx4 v4, s[20:23], s51 offen lds
    s_mov_b64 exec, -1
    s_add_u32 s51, s51, 14336
k1g_5:
    v_mfma_f32_16x16x32_bf16 v[140:143], v[56:59], v[40:43], v[140:143]
    ds_read_b64_tr_b16 v[80:81], v24 offset:8192
    ds_read_b64_tr_b16 v[82:83], v24 offset:9216
    v_mfma_f32_16x16x32_bf16 v[124:127], v[60:63], v[36:39], v[124:127]
    v_mfma_f32_16x16x32_bf16 v[144:147], v[60:63], v[40:43], v[144:147]
    v_mfma_f32_16x16x32_bf16 v[156:159], v[36:39], v[36:39], v[156:159]
    s_cmp_ge_u32 s38, 7
    s_cbranch_scc1 k1g_6
    s_mov_b64 exec, s[40:41]
    buffer_load_dwordx4 v4, s[20:23], s51 offen offset:1024 lds
    s_mov_b64 exec, -1
    s_add_u32 s39, s39, 32768
    s_and_b32 s39, s39, 131071
    s_add_u32 s49, s49, 1
    s_cmp_eq_u32 s49, 10
    s_cselect_b32 s49, 0, s49
k1g_6:
    v_mfma_f32_16x16x32_bf16 v[160:163], v[40:43], v[40:43], v[160:163]
    s_cmp_lg_u32 s60, 0
    s_cbranch_scc1 k1_kernel_cs_7
    s_cmp_lg_u32 s61, 0
    s_cbranch_scc1 k1_kernel_ch_8
    v_mfma_f32_16x16x32_bf16 v[164:167], v[32:35], v[52:55], v[164:167]
    v_mfma_f32_16x16x32_bf16 v[168:171], v[32:35], v[56:59], v[168:171]
    s_branch k1_kernel_cs_7
k1_kernel_ch_8:
    v_mfma_f32_16x16x32_bf16 v[164:167], v[32:35], v[60:63], v[164:167]
k1_kernel_cs_7:
    s_add_u32 s37, s37, 32768
    s_and_b32 s37, s37, 131071
    s_waitcnt lgkmcnt(0)
    v_add_u32 v12, s37, v10
    v_add_u32 v13, s37, v11
    v_add_u32 v22, s37, v14
    v_add_u32 v23, s37, v15
    v_add_u32 v24, s37, v16
    s_cmp_ge_u32 s38, 7
    s_cbranch_scc1 k1w_9
    s_waitcnt vmcnt(8)
    s_branch k1w2_10
k1w_9:
    s_waitcnt vmcnt(0)
k1w2_10:
    s_barrier
    s_cmp_le_u32 s38, 3
    s_cbranch_scc1 k1_kernel_exs
k1_kernel_exr0:
    v_mfma_f32_16x16x32_bf16 v[116:119], v[72:75], v[44:47], v[116:119]
    ds_read_b128 v[36:39], v12 offset:0
    ds_read_b128 v[40:43], v12 offset:2048
    v_mfma_f32_16x16x32_bf16 v[136:139], v[72:75], v[48:51], v[136:139]
    ds_read_b64_tr_b16 v[52:53], v22 offset:0
    ds_read_b64_tr_b16 v[54:55], v22 offset:1024
    v_mfma_f32_16x16x32_bf16 v[120:123], v[76:79], v[44:47], v[120:123]
    ds_read_b64_tr_b16 v[56:57], v23 offset:0
    ds_read_b64_tr_b16 v[58:59], v23 offset:1024
    s_cmp_ge_u32 s38, 6
    s_cbranch_scc1 k1g_11
    s_mov_b32 m0, s36
    s_lshl_b32 s50, s48, 7
    buffer_load_dwordx4 v2, s[16:19], s50 offen lds
    s_add_u32 s50, s50, 9216
k1g_11:
    v_mfma_f32_16x16x32_bf16 v[140:143], v[76:79], v[48:51], v[140:143]
    ds_read_b64_tr_b16 v[60:61], v24 offset:0
    ds_read_b64_tr_b16 v[62:63], v24 offset:1024
    v_mfma_f32_16x16x32_bf16 v[124:127], v[80:83], v[44:47], v[124:127]
    v_mfma_f32_16x16x32_bf16 v[144:147], v[80:83], v[48:51], v[144:147]
    v_mfma_f32_16x16x32_bf16 v[156:159], v[44:47], v[44:47], v[156:159]
    s_cmp_ge_u32 s38, 6
    s_cbranch_scc1 k1g_12
    buffer_load_dwordx4 v3, s[16:19], s50 offen offset:1024 lds
    s_add_u32 s36, s36, 32768
    s_and_b32 s36, s36, 131071
    s_add_u32 s48, s48, 1
    s_cmp_eq_u32 s48, 10
    s_cselect_b32 s48, 0, s48
k1g_12:
    v_mfma_f32_16x16x32_bf16 v[160:163], v[48:51], v[48:51], v[160:163]
    s_cmp_lg_u32 s60, 1
    s_cbranch_scc1 k1_kernel_cs_13
    s_cmp_lg_u32 s61, 0
    s_cbranch_scc1 k1_kernel_ch_14
    v_mfma_f32_16x16x32_bf16 v[164:167], v[32:35], v[72:75], v[164:167]
    v_mfma_f32_16x16x32_bf16 v[168:171], v[32:35], v[76:79], v[168:171]
    s_branch k1_kernel_cs_13
k1_kernel_ch_14:
    v_mfma_f32_16x16x32_bf16 v[164:167], v[32:35], v[80:83], v[164:167]
k1_kernel_cs_13:
    s_add_u32 s38, s38, 1
    s_cmp_lt_u32 s38, 10
    s_waitcnt lgkmcnt(0)
    s_cbranch_scc1 k1_kernel_loop0
    s_branch k1_kernel_epi
k1_kernel_r1:
    ds_read_b128 v[36:39], v12 offset:0
    ds_read_b128 v[40:43], v12 offset:2048
    ds_read_b64_tr_b16 v[52:53], v22 offset:0
    ds_read_b64_tr_b16 v[54:55], v22 offset:1024
    ds_read_b64_tr_b16 v[56:57], v23 offset:0
    ds_read_b64_tr_b16 v[58:59], v23 offset:1024
    ds_read_b64_tr_b16 v[60:61], v24 offset:0
    ds_read_b64_tr_b16 v[62:63], v24 offset:1024
    ds_read_b64_tr_b16 v[64:65], v25 offset:0
    ds_read_b64_tr_b16 v[66:67], v25 offset:1024
    ds_read_b64_tr_b16 v[68:69], v26 offset:0
    ds_read_b64_tr_b16 v[70:71], v26 offset:1024
    s_waitcnt lgkmcnt(0)
k1_kernel_loop1:
    v_mfma_f32_16x16x32_bf16 v[116:119], v[36:39], v[52:55], v[116:119]
    ds_read_b128 v[44:47], v13 offset:0
    ds_read_b128 v[48:51], v13 offset:2048
    v_mfma_f32_16x16x32_bf16 v[136:139], v[40:43], v[52:55], v[136:139]
    ds_read_b64_tr_b16 v[72:73], v22 offset:8192
    ds_read_b64_tr_b16 v[74:75], v22 offset:9216
    v_mfma_f32_16x16x32_bf16 v[120:123], v[36:39], v[56:59], v[120:123]
    ds_read_b64_tr_b16 v[76:77], v23 offset:8192
    ds_read_b64_tr_b16 v[78:79], v23 offset:9216
    s_cmp_ge_u32 s38, 7
    s_cbranch_scc1 k1g_15
    s_mov_b32 m0, s39
    s_mul_i32 s51, s49, 245760
    s_mov_b64 exec, s[40:41]
    buffer_load_dwordx4 v4, s[20:23], s51 offen lds
    s_mov_b64 exec, -1
    s_add_u32 s51, s51, 14336
k1g_15:
    v_mfma_f32_16x16x32_bf16 v[140:143], v[40:43], v[56:59], v[140:143]
    ds_read_b64_tr_b16 v[80:81], v24 offset:8192
    ds_read_b64_tr_b16 v[82:83], v24 offset:9216
    v_mfma_f32_16x16x32_bf16 v[124:127], v[36:39], v[60:63], v[124:127]
    ds_read_b64_tr_b16 v[84:85], v25 offset:8192
    ds_read_b64_tr_b16 v[86:87], v25 offset:9216
    v_mfma_f32_16x16x32_bf16 v[144:147], v[40:43], v[60:63], v[144:147]
    ds_read_b64_tr_b16 v[88:89], v26 offset:8192
    ds_read_b64_tr_b16 v[90:91], v26 offset:9216
    v_mfma_f32_16x16x32_bf16 v[128:131], v[36:39], v[64:67], v[128:131]
    s_cmp_ge_u32 s38, 7
    s_cbranch_scc1 k1g_16
    s_mov_b64 exec, s[40:41]
    buffer_load_dwordx4 v4, s[20:23], s51 offen offset:1024 lds
    s_mov_b64 exec, -1
    s_add_u32 s39, s39, 32768
    s_and_b32 s39, s39, 131071
    s_add_u32 s49, s49, 1
    s_cmp_eq_u32 s49, 10
    s_cselect_b32 s49, 0, s49
k1g_16:
    v_mfma_f32_16x16x32_bf16 v[148:151], v[40:43], v[64:67], v[148:151]
    v_mfma_f32_16x16x32_bf16 v[132:135], v[36:39], v[68:71], v[132:135]
    v_mfma_f32_16x16x32_bf16 v[152:155], v[40:43], v[68:71], v[152:155]
    s_cmp_lg_u32 s60, 0
    s_cbranch_scc1 k1_kernel_cs_17
    s_cmp_lg_u32 s61, 0
    s_cbranch_scc1 k1_kernel_ch_18
    v_mfma_f32_16x16x32_bf16 v[164:167], v[32:35], v[52:55], v[164:167]
    v_mfma_f32_16x16x32_bf16 v[168:171], v[32:35], v[56:59], v[168:171]
    v_mfma_f32_16x16x32_bf16 v[172:175], v[32:35], v[60:63], v[172:175]
    s_branch k1_kernel_cs_17
k1_kernel_ch_18:
    v_mfma_f32_16x16x32_bf16 v[164:167], v[32:35], v[64:67], v[164:167]
    v_mfma_f32_16x16x32_bf16 v[168:171], v[32:35], v[68:71], v[168:171]
k1_kernel_cs_17:
    s_add_u32 s37, s37, 32768
    s_and_b32 s37, s37, 131071
    s_waitcnt lgkmcnt(0)
    v_add_u32 v12, s37, v10
    v_add_u32 v13, s37, v11
    v_add_u32 v22, s37, v14
    v_add_u32 v23, s37, v15
    v_add_u32 v24, s37, v16
    v_add_u32 v25, s37, v17
    v_add_u32 v26, s37, v18
    s_cmp_ge_u32 s38, 7
    s_cbranch_scc1 k1w_19
    s_waitcnt vmcnt(8)
    s_branch k1w2_20
k1w_19:
    s_waitcnt vmcnt(0)
k1w2_20:
    s_barrier
    s_cmp_le_u32 s38, 3
    s_cbranch_scc1 k1_kernel_exs
k1_kernel_exr1:
    v_mfma_f32_16x16x32_bf16 v[116:119], v[44:47], v[72:75], v[116:119]
    ds_read_b128 v[36:39], v12 offset:0
    ds_read_b128 v[40:43], v12 offset:2048
    v_mfma_f32_16x16x32_bf16 v[136:139], v[48:51], v[72:75], v[136:139]
    ds_read_b64_tr_b16 v[52:53], v22 offset:0
    ds_read_b64_tr_b16 v[54:55], v22 offset:1024
    v_mfma_f32_16x16x32_bf16 v[120:123], v[44:47], v[76:79], v[120:123]
    ds_read_b64_tr_b16 v[56:57], v23 offset:0
    ds_read_b64_tr_b16 v[58:59], v23 offset:1024
    s_cmp_ge_u32 s38, 6
    s_cbranch_scc1 k1g_21
    s_mov_b32 m0, s36
    s_lshl_b32 s50, s48, 7
    buffer_load_dwordx4 v2, s[16:19], s50 offen lds
    s_add_u32 s50, s50, 9216
k1g_21:
    v_mfma_f32_16x16x32_bf16 v[140:143], v[48:51], v[76:79], v[140:143]
    ds_read_b64_tr_b16 v[60:61], v24 offset:0
    ds_read_b64_tr_b16 v[62:63], v24 offset:1024
    v_mfma_f32_16x16x32_bf16 v[124:127], v[44:47], v[80:83], v[124:127]
    ds_read_b64_tr_b16 v[64:65], v25 offset:0
    ds_read_b64_tr_b16 v[66:67], v25 offset:1024
    v_mfma_f32_16x16x32_bf16 v[144:147], v[48:51], v[80:83], v[144:147]
    ds_read_b64_tr_b16 v[68:69], v26 offset:0
    ds_read_b64_tr_b16 v[70:71], v26 offset:1024
    v_mfma_f32_16x16x32_bf16 v[128:131], v[44:47], v[84:87], v[128:131]
    s_cmp_ge_u32 s38, 6
    s_cbranch_scc1 k1g_22
    buffer_load_dwordx4 v3, s[16:19], s50 offen offset:1024 lds
    s_add_u32 s36, s36, 32768
    s_and_b32 s36, s36, 131071
    s_add_u32 s48, s48, 1
    s_cmp_eq_u32 s48, 10
    s_cselect_b32 s48, 0, s48
k1g_22:
    v_mfma_f32_16x16x32_bf16 v[148:151], v[48:51], v[84:87], v[148:151]
    v_mfma_f32_16x16x32_bf16 v[132:135], v[44:47], v[88:91], v[132:135]
    v_mfma_f32_16x16x32_bf16 v[152:155], v[48:51], v[88:91], v[152:155]
    s_cmp_lg_u32 s60, 1
    s_cbranch_scc1 k1_kernel_cs_23
    s_cmp_lg_u32 s61, 0
    s_cbranch_scc1 k1_kernel_ch_24
    v_mfma_f32_16x16x32_bf16 v[164:167], v[32:35], v[72:75], v[164:167]
    v_mfma_f32_16x16x32_bf16 v[168:171], v[32:35], v[76:79], v[168:171]
    v_mfma_f32_16x16x32_bf16 v[172:175], v[32:35], v[80:83], v[172:175]
    s_branch k1_kernel_cs_23
k1_kernel_ch_24:
    v_mfma_f32_16x16x32_bf16 v[164:167], v[32:35], v[84:87], v[164:167]
    v_mfma_f32_16x16x32_bf16 v[168:171], v[32:35], v[88:91], v[168:171]
k1_kernel_cs_23:
    s_add_u32 s38, s38, 1
    s_cmp_lt_u32 s38, 10
    s_waitcnt lgkmcnt(0)
    s_cbranch_scc1 k1_kernel_loop1
    s_branch k1_kernel_epi
k1_kernel_exs:
    s_cmp_lg_u32 s38, 0
    s_cbranch_scc1 k1_ex_25
    s_and_b32 s15, s13, 7
    s_lshr_b32 s33, s15, 1
    s_lshr_b32 s34, s13, 3
    s_lshl_b32 s34, s34, 2
    s_add_u32 s33, s33, s34
    s_lshl_b32 s34, s12, 3
    s_add_u32 s33, s33, s34
    s_lshr_b32 s35, 0xa5, s15
    s_and_b32 s35, s35, 1
    s_lshl_b32 s34, s33, 3
    s_add_u32 s34, s34, s14
    s_lshl_b32 s33, s33, 1
    s_add_u32 s33, s33, s14
    s_add_u32 s33, s33, 1024
    s_cmp_eq_u32 s35, 1
    s_cselect_b32 s33, s34, s33
    s_cmp_lt_u32 s14, 2
    s_cselect_b32 s35, 1, s35
    s_cmp_eq_u32 s35, 1
    s_cselect_b32 s33, s33, 0
    s_lshl_b32 s34, s14, 12
    s_add_u32 s34, s34, 131072
    s_cmp_eq_u32 s35, 0
    s_cbranch_scc1 k1rs_26
    s_cmp_ge_u32 s33, 540
    s_cselect_b32 s91, 1, 0
    s_cmp_ge_u32 s33, 1080
    s_cselect_b32 s91, 2, s91
    s_mul_i32 s92, s91, 540
    s_sub_u32 s92, s33, s92
    s_mul_hi_u32 s89, s92, 0x97b425f
    s_mul_i32 s93, s89, 27
    s_sub_u32 s90, s92, s93
    s_mul_hi_u32 s93, s92, 0x1999999a
    s_mul_i32 s94, s93, 10
    s_sub_u32 s94, s92, s94
    s_cmp_eq_u32 s91, 0
    s_cselect_b32 s89, s89, s93
    s_cselect_b32 s90, s90, s94
    s_movk_i32 s88, 1280
    s_cselect_b32 s88, 3456, s88
    s_cselect_b32 s84, s80, s82
    s_cselect_b32 s85, s81, s83
    s_mov_b32 s86, 2211840
    s_cselect_b32 s86, 2211840, s86
    s_cmp_eq_u32 s91, 2
    s_cselect_b32 s84, s66, s84
    s_cselect_b32 s85, s67, s85
    s_cselect_b32 s86, 819200, s86
    s_and_b32 s85, s85, 0xffff
    s_mov_b32 s87, 0x00020000
    s_mul_i32 s86, s86, s35
    v_lshrrev_b32 v180, 3, v1
    v_add_u32 v183, 12, v180
    v_cmp_gt_u32 vcc, 4, v180
    s_lshl_b32 s92, s89, 5
    v_cndmask_b32 v181, v183, v180, vcc
    v_add_u32 v181, s92, v181
    v_mov_b32 v182, 4
    s_cmp_lg_u32 s91, 2
    s_cbranch_scc1 rp_nwo_27
    s_mul_i32 s92, s89, 13
    s_lshr_b32 s92, s92, 6
    s_mul_i32 s93, s92, 5
    s_sub_u32 s93, s89, s93
    s_lshl_b32 s93, s93, 3
    v_add_u32 v183, s93, v180
    v_mul_u32_u24 v184, 13, v183
    v_lshrrev_b32 v184, 6, v184
    v_mul_u32_u24 v181, 5, v184
    v_sub_u32 v183, v183, v181
    v_mul_u32_u24 v181, 20, v184
    s_mul_i32 s92, s92, 160
    v_add_u32 v181, s92, v181
    v_cmp_gt_u32 vcc, 4, v183
    v_mov_b32 v184, 16
    v_mov_b32 v182, 1
    v_cndmask_b32 v184, v184, v183, vcc
    v_add_u32 v181, v181, v184
    v_mov_b32 v184, 4
    v_cndmask_b32 v182, v182, v184, vcc
rp_nwo_27:
    v_mul_lo_u32 v181, v181, s88
    v_mul_lo_u32 v182, v182, s88
    v_and_b32 v183, 7, v1
    v_lshl_add_u32 v181, v183, 4, v181
    s_lshl_b32 s92, s90, 7
    v_add_u32 v181, s92, v181
    s_mov_b32 m0, s34
    v_subrev_u32 v185, 0, v181
    buffer_load_dwordx4 v185, s[84:87], 0 offen offset:0 lds
    v_add_u32 v181, v181, v182
    v_subrev_u32 v185, 1024, v181
    buffer_load_dwordx4 v185, s[84:87], 0 offen offset:1024 lds
    v_add_u32 v181, v181, v182
    v_subrev_u32 v185, 2048, v181
    buffer_load_dwordx4 v185, s[84:87], 0 offen offset:2048 lds
    v_add_u32 v181, v181, v182
    v_subrev_u32 v185, 3072, v181
    buffer_load_dwordx4 v185, s[84:87], 0 offen offset:3072 lds
k1rs_26:
    v_mov_b32 v188, 0
    v_mov_b32 v189, 0
    v_mov_b32 v190, 0
    v_mov_b32 v191, 0
    s_lshl_b32 s15, s13, 12
    s_add_u32 s15, s15, 3145728
    s_add_u32 s24, s10, s15
    s_addc_u32 s25, s11, 0
    s_and_b32 s25, s25, 0xffff
    s_mov_b32 s26, 0x1000
    s_mov_b32 s27, 0x00020000
    s_or_b32 s15, s12, s14
    s_cmp_eq_u32 s15, 0
    s_cselect_b32 s46, 4096, 0
    s_mov_b32 s26, s46
    s_cmp_eq_u32 s46, 0
    s_cbranch_scc1 k1zs_28
    v_lshlrev_b32 v6, 4, v1
    buffer_store_dwordx4 v[188:191], v6, s[24:27], 0 offen offset:0 sc1
    buffer_store_dwordx4 v[188:191], v6, s[24:27], 0 offen offset:1024 sc1
    buffer_store_dwordx4 v[188:191], v6, s[24:27], 0 offen offset:2048 sc1
    buffer_store_dwordx4 v[188:191], v6, s[24:27], 0 offen offset:3072 sc1
k1zs_28:
    s_mov_b32 s26, 4096
    s_mov_b32 s28, s8
    s_and_b32 s29, s9, 0xffff
    s_mov_b32 s30, 0x100
    s_mov_b32 s31, 0x00020000
k1_ex_25:
    s_cmp_lg_u32 s38, 3
    s_cbranch_scc1 k1_fl_29
    s_cmp_eq_u32 s46, 0
    s_cbranch_scc1 k1_fl_29
    v_mov_b32 v6, 1
    s_lshl_b32 s15, s13, 2
    s_add_u32 s15, s15, 128
    v_mov_b32 v7, s15
    s_lshr_b32 s30, s46, 4
    s_min_u32 s30, s30, 256
    s_mov_b64 exec, 1
    buffer_store_dword v6, v7, s[28:31], 0 offen sc1
    s_mov_b64 exec, -1
    s_movk_i32 s30, 256
k1_fl_29:
    s_cmp_eq_u32 s58, 0
    s_cbranch_scc1 k1_kernel_exr0
    s_branch k1_kernel_exr1
k1_kernel_epi:
    s_lshl_b32 s15, s13, 2
    s_add_u32 s15, s15, 128
    v_mov_b32 v30, s15
    buffer_load_dword v31, v30, s[28:31], 0 offen sc1
    s_barrier
    v_and_b32 v10, 15, v1
    v_lshrrev_b32 v11, 4, v1
    s_lshl_b32 s15, s59, 8
    v_lshl_add_u32 v12, v10, 3, s15
    v_lshl_add_u32 v13, v11, 5, s15
    s_mul_i32 s62, s61, 2
    s_mul_i32 s63, s61, 3
    s_add_u32 s63, s63, 3
    s_cmp_eq_u32 s58, 0
    s_cselect_b32 s62, s62, s63
    s_lshl_b32 s62, s62, 6
    s_lshl_b32 s63, s60, 9
    s_add_u32 s62, s62, s63
    v_lshl_add_u32 v14, v10, 2, s62
    s_lshl_b32 s63, s58, 0
    s_add_u32 s63, s63, 2
    s_sub_u32 s63, s63, s61
    s_mov_b64 exec, 0xffff
    ds_write_b32 v14, v164 offset:1024
    s_cmp_lt_u32 s63, 2
    s_cbranch_scc1 k1cw_30
    ds_write_b32 v14, v168 offset:1088
    s_cmp_lt_u32 s63, 3
    s_cbranch_scc1 k1cw_30
    ds_write_b32 v14, v172 offset:1152
k1cw_30:
    s_mov_b64 exec, -1
    s_cmp_lg_u32 s58, 0
    s_cbranch_scc1 k1_kernel_e1a
    s_mov_b32 s62, 0
    s_mov_b32 s63, 0xffff
    s_mov_b64 exec, s[62:63]
    ds_write_b32 v12, v124 offset:0
    ds_write_b32 v12, v144 offset:128
    s_mov_b64 exec, -1
    v_and_b32 v6, 3, v1
    v_mov_b32 v15, v156
    v_mov_b32 v16, v160
    v_cmp_eq_u32 vcc, 1, v6
    s_nop 1
    v_cndmask_b32 v15, v15, v157, vcc
    v_cndmask_b32 v16, v16, v161, vcc
    v_cmp_eq_u32 vcc, 2, v6
    s_nop 1
    v_cndmask_b32 v15, v15, v158, vcc
    v_cndmask_b32 v16, v16, v162, vcc
    v_cmp_eq_u32 vcc, 3, v6
    s_nop 1
    v_cndmask_b32 v15, v15, v159, vcc
    v_cndmask_b32 v16, v16, v163, vcc
    v_lshrrev_b32 v7, 2, v10
    v_cmp_eq_u32 vcc, v7, v11
    s_nop 1
    s_and_saveexec_b64 s[62:63], vcc
    ds_write_b32 v12, v15 offset:4
    ds_write_b32 v12, v16 offset:132
    s_mov_b64 exec, -1
k1_kernel_e1a:
    s_waitcnt lgkmcnt(0)
    s_barrier
    s_cmp_eq_u32 s35, 0
    s_cbranch_scc1 k1_rpf_31
    s_waitcnt vmcnt(1)
    s_cmp_ge_u32 s33, 540
    s_cselect_b32 s91, 1, 0
    s_cmp_ge_u32 s33, 1080
    s_cselect_b32 s91, 2, s91
    s_mul_i32 s92, s91, 540
    s_sub_u32 s92, s33, s92
    s_mul_hi_u32 s89, s92, 0x97b425f
    s_mul_i32 s93, s89, 27
    s_sub_u32 s90, s92, s93
    s_mul_hi_u32 s93, s92, 0x1999999a
    s_mul_i32 s94, s93, 10
    s_sub_u32 s94, s92, s94
    s_cmp_eq_u32 s91, 0
    s_cselect_b32 s89, s89, s93
    s_cselect_b32 s90, s90, s94
    s_movk_i32 s88, 1280
    s_cselect_b32 s88, 3456, s88
    s_cselect_b32 s84, s80, s82
    s_cselect_b32 s85, s81, s83
    s_mov_b32 s86, 2211840
    s_cselect_b32 s86, 2211840, s86
    s_cmp_eq_u32 s91, 2
    s_cselect_b32 s84, s66, s84
    s_cselect_b32 s85, s67, s85
    s_cselect_b32 s86, 819200, s86
    s_and_b32 s85, s85, 0xffff
    s_mov_b32 s87, 0x00020000
    v_lshrrev_b32 v180, 4, v1
    v_bfe_u32 v181, v1, 2, 2
    v_lshl_add_u32 v180, v180, 3, v181
    v_lshlrev_b32 v180, 7, v180
    v_and_b32 v181, 3, v1
    v_lshl_add_u32 v180, v181, 3, v180
    v_add_u32 v180, s34, v180
    ds_read_b64_tr_b16 v[184:185], v180 offset:0
    ds_read_b64_tr_b16 v[186:187], v180 offset:512
    ds_read_b64_tr_b16 v[188:189], v180 offset:32
    ds_read_b64_tr_b16 v[190:191], v180 offset:544
    ds_read_b64_tr_b16 v[192:193], v180 offset:64
    ds_read_b64_tr_b16 v[194:195], v180 offset:576
    ds_read_b64_tr_b16 v[196:197], v180 offset:96
    ds_read_b64_tr_b16 v[198:199], v180 offset:608
    v_lshlrev_b32 v181, 4, v1
    s_mov_b32 s96, s10
    s_and_b32 s97, s11, 0xffff
    s_mov_b32 s98, 0x2000000
    s_mov_b32 s99, 0x00020000
    s_lshl_b32 s92, s90, 2
    s_add_u32 s92, s92, 0
    s_mul_i32 s93, s92, 205
    s_lshr_b32 s93, s93, 10
    s_mul_i32 s94, s93, 5
    s_sub_u32 s94, s92, s94
    s_cmp_eq_u32 s91, 1
    s_cselect_b32 s95, 54, 20
    s_mul_i32 s93, s93, s95
    s_add_u32 s93, s93, s89
    s_mul_i32 s93, s93, 5
    s_add_u32 s93, s93, s94
    s_mul_i32 s94, s89, 108
    s_add_u32 s94, s94, s92
    s_cmp_eq_u32 s91, 0
    s_cselect_b32 s93, s94, s93
    s_mov_b32 s94, 20971520
    s_cselect_b32 s94, 17825792, s94
    s_lshl_b32 s93, s93, 10
    s_cmp_eq_u32 s91, 2
    s_cselect_b32 s94, 16777216, s94
    s_add_u32 s93, s93, s94
    s_waitcnt lgkmcnt(0)
    buffer_store_dwordx4 v[184:187], v181, s[96:99], s93 offen
    s_lshl_b32 s92, s90, 2
    s_add_u32 s92, s92, 1
    s_mul_i32 s93, s92, 205
    s_lshr_b32 s93, s93, 10
    s_mul_i32 s94, s93, 5
    s_sub_u32 s94, s92, s94
    s_cmp_eq_u32 s91, 1
    s_cselect_b32 s95, 54, 20
    s_mul_i32 s93, s93, s95
    s_add_u32 s93, s93, s89
    s_mul_i32 s93, s93, 5
    s_add_u32 s93, s93, s94
    s_mul_i32 s94, s89, 108
    s_add_u32 s94, s94, s92
    s_cmp_eq_u32 s91, 0
    s_cselect_b32 s93, s94, s93
    s_mov_b32 s94, 20971520
    s_cselect_b32 s94, 17825792, s94
    s_lshl_b32 s93, s93, 10
    s_cmp_eq_u32 s91, 2
    s_cselect_b32 s94, 16777216, s94
    s_add_u32 s93, s93, s94
    buffer_store_dwordx4 v[188:191], v181, s[96:99], s93 offen
    s_lshl_b32 s92, s90, 2
    s_add_u32 s92, s92, 2
    s_mul_i32 s93, s92, 205
    s_lshr_b32 s93, s93, 10
    s_mul_i32 s94, s93, 5
    s_sub_u32 s94, s92, s94
    s_cmp_eq_u32 s91, 1
    s_cselect_b32 s95, 54, 20
    s_mul_i32 s93, s93, s95
    s_add_u32 s93, s93, s89
    s_mul_i32 s93, s93, 5
    s_add_u32 s93, s93, s94
    s_mul_i32 s94, s89, 108
    s_add_u32 s94, s94, s92
    s_cmp_eq_u32 s91, 0
    s_cselect_b32 s93, s94, s93
    s_mov_b32 s94, 20971520
    s_cselect_b32 s94, 17825792, s94
    s_lshl_b32 s93, s93, 10
    s_cmp_eq_u32 s91, 2
    s_cselect_b32 s94, 16777216, s94
    s_add_u32 s93, s93, s94
    buffer_store_dwordx4 v[192:195], v181, s[96:99], s93 offen
    s_lshl_b32 s92, s90, 2
    s_add_u32 s92, s92, 3
    s_mul_i32 s93, s92, 205
    s_lshr_b32 s93, s93, 10
    s_mul_i32 s94, s93, 5
    s_sub_u32 s94, s92, s94
    s_cmp_eq_u32 s91, 1
    s_cselect_b32 s95, 54, 20
    s_mul_i32 s93, s93, s95
    s_add_u32 s93, s93, s89
    s_mul_i32 s93, s93, 5
    s_add_u32 s93, s93, s94
    s_mul_i32 s94, s89, 108
    s_add_u32 s94, s94, s92
    s_cmp_eq_u32 s91, 0
    s_cselect_b32 s93, s94, s93
    s_mov_b32 s94, 20971520
    s_cselect_b32 s94, 17825792, s94
    s_lshl_b32 s93, s93, 10
    s_cmp_eq_u32 s91, 2
    s_cselect_b32 s94, 16777216, s94
    s_add_u32 s93, s93, s94
    buffer_store_dwordx4 v[196:199], v181, s[96:99], s93 offen
k1_rpf_31:
    s_mov_b32 s60, 0x3acccccd
    s_mov_b32 s61, 0x3727c5ac
    s_mov_b32 s62, 0x3fb8aa3b
    s_mov_b32 s63, 0x358637bd
    s_cmp_lg_u32 s58, 0
    s_cbranch_scc1 k1_kernel_e1b
    ds_read_b64 v[16:17], v12 offset:0
    ds_read_b64 v[18:19], v12 offset:128
    v_lshlrev_b32 v20, 4, v11
    ds_read_b128 v[52:55], v20 offset:1024
    ds_read_b128 v[56:59], v20 offset:1536
    ds_read_b128 v[60:63], v20 offset:1088
    ds_read_b128 v[64:67], v20 offset:1600
    ds_read_b128 v[68:71], v20 offset:1152
    ds_read_b128 v[72:75], v20 offset:1664
    s_waitcnt lgkmcnt(0)
    v_mul_f32 v16, s60, v16
    v_mul_f32 v17, s60, v17
    v_mul_f32 v18, s60, v18
    v_mul_f32 v19, s60, v19
    v_fma_f32 v17, -v16, v16, v17
    v_fma_f32 v19, -v18, v18, v19
    v_add_f32 v17, s61, v17
    v_add_f32 v19, s61, v19
    v_rsq_f32 v17, v17
    v_rsq_f32 v19, v19
    v_sub_f32 v16, 0, v16
    v_sub_f32 v18, 0, v18
    v_add_f32 v52, v52, v56
    v_add_f32 v53, v53, v57
    v_add_f32 v54, v54, v58
    v_add_f32 v55, v55, v59
    v_add_f32 v60, v60, v64
    v_add_f32 v61, v61, v65
    v_add_f32 v62, v62, v66
    v_add_f32 v63, v63, v67
    v_add_f32 v68, v68, v72
    v_add_f32 v69, v69, v73
    v_add_f32 v70, v70, v74
    v_add_f32 v71, v71, v75
    v_fma_f32 v116, v16, v52, v116
    v_fma_f32 v117, v16, v53, v117
    v_fma_f32 v118, v16, v54, v118
    v_fma_f32 v119, v16, v55, v119
    v_fma_f32 v120, v16, v60, v120
    v_fma_f32 v121, v16, v61, v121
    v_fma_f32 v122, v16, v62, v122
    v_fma_f32 v123, v16, v63, v123
    v_fma_f32 v124, v16, v68, v124
    v_fma_f32 v125, v16, v69, v125
    v_fma_f32 v126, v16, v70, v126
    v_fma_f32 v127, v16, v71, v127
    v_fma_f32 v136, v18, v52, v136
    v_fma_f32 v137, v18, v53, v137
    v_fma_f32 v138, v18, v54, v138
    v_fma_f32 v139, v18, v55, v139
    v_fma_f32 v140, v18, v60, v140
    v_fma_f32 v141, v18, v61, v141
    v_fma_f32 v142, v18, v62, v142
    v_fma_f32 v143, v18, v63, v143
    v_fma_f32 v144, v18, v68, v144
    v_fma_f32 v145, v18, v69, v145
    v_fma_f32 v146, v18, v70, v146
    v_fma_f32 v147, v18, v71, v147
    v_mul_f32 v116, v116, v17
    v_mul_f32 v117, v117, v17
    v_mul_f32 v118, v118, v17
    v_mul_f32 v119, v119, v17
    v_mul_f32 v120, v120, v17
    v_mul_f32 v121, v121, v17
    v_mul_f32 v122, v122, v17
    v_mul_f32 v123, v123, v17
    v_mul_f32 v124, v124, v17
    v_mul_f32 v125, v125, v17
    v_mul_f32 v126, v126, v17
    v_mul_f32 v127, v127, v17
    v_mul_f32 v136, v136, v19
    v_mul_f32 v137, v137, v19
    v_mul_f32 v138, v138, v19
    v_mul_f32 v139, v139, v19
    v_mul_f32 v140, v140, v19
    v_mul_f32 v141, v141, v19
    v_mul_f32 v142, v142, v19
    v_mul_f32 v143, v143, v19
    v_mul_f32 v144, v144, v19
    v_mul_f32 v145, v145, v19
    v_mul_f32 v146, v146, v19
    v_mul_f32 v147, v147, v19
    v_mul_f32 v200, s62, v116
    v_mul_f32 v201, s62, v117
    v_mul_f32 v202, s62, v118
    v_mul_f32 v203, s62, v119
    v_mul_f32 v204, s62, v120
    v_mul_f32 v205, s62, v121
    v_mul_f32 v206, s62, v122
    v_mul_f32 v207, s62, v123
    v_mul_f32 v208, s62, v124
    v_mul_f32 v209, s62, v125
    v_mul_f32 v210, s62, v126
    v_mul_f32 v211, s62, v127
    v_mul_f32 v212, s62, v136
    v_mul_f32 v213, s62, v137
    v_mul_f32 v214, s62, v138
    v_mul_f32 v215, s62, v139
    v_mul_f32 v216, s62, v140
    v_mul_f32 v217, s62, v141
    v_mul_f32 v218, s62, v142
    v_mul_f32 v219, s62, v143
    v_mul_f32 v220, s62, v144
    v_mul_f32 v221, s62, v145
    v_mul_f32 v222, s62, v146
    v_mul_f32 v223, s62, v147
    v_exp_f32 v200, v200 clamp
    v_exp_f32 v201, v201 clamp
    v_exp_f32 v202, v202 clamp
    v_exp_f32 v203, v203 clamp
    v_exp_f32 v204, v204 clamp
    v_exp_f32 v205, v205 clamp
    v_exp_f32 v206, v206 clamp
    v_exp_f32 v207, v207 clamp
    v_exp_f32 v208, v208 clamp
    v_exp_f32 v209, v209 clamp
    v_exp_f32 v210, v210 clamp
    v_exp_f32 v211, v211 clamp
    v_exp_f32 v212, v212 clamp
    v_exp_f32 v213, v213 clamp
    v_exp_f32 v214, v214 clamp
    v_exp_f32 v215, v215 clamp
    v_exp_f32 v216, v216 clamp
    v_exp_f32 v217, v217 clamp
    v_exp_f32 v218, v218 clamp
    v_exp_f32 v219, v219 clamp
    v_exp_f32 v220, v220 clamp
    v_exp_f32 v221, v221 clamp
    v_exp_f32 v222, v222 clamp
    v_exp_f32 v223, v223 clamp
    v_max_f32 v116, 0, v116
    v_max_f32 v117, 0, v117
    v_max_f32 v118, 0, v118
    v_max_f32 v119, 0, v119
    v_max_f32 v120, 0, v120
    v_max_f32 v121, 0, v121
    v_max_f32 v122, 0, v122
    v_max_f32 v123, 0, v123
    v_max_f32 v124, 0, v124
    v_max_f32 v125, 0, v125
    v_max_f32 v126, 0, v126
    v_max_f32 v127, 0, v127
    v_max_f32 v136, 0, v136
    v_max_f32 v137, 0, v137
    v_max_f32 v138, 0, v138
    v_max_f32 v139, 0, v139
    v_max_f32 v140, 0, v140
    v_max_f32 v141, 0, v141
    v_max_f32 v142, 0, v142
    v_max_f32 v143, 0, v143
    v_max_f32 v144, 0, v144
    v_max_f32 v145, 0, v145
    v_max_f32 v146, 0, v146
    v_max_f32 v147, 0, v147
    v_add_f32 v200, s63, v200
    v_add_f32 v201, s63, v201
    v_add_f32 v202, s63, v202
    v_add_f32 v203, s63, v203
    v_add_f32 v204, s63, v204
    v_add_f32 v205, s63, v205
    v_add_f32 v206, s63, v206
    v_add_f32 v207, s63, v207
    v_add_f32 v208, s63, v208
    v_add_f32 v209, s63, v209
    v_add_f32 v210, s63, v210
    v_add_f32 v211, s63, v211
    v_add_f32 v212, s63, v212
    v_add_f32 v213, s63, v213
    v_add_f32 v214, s63, v214
    v_add_f32 v215, s63, v215
    v_add_f32 v216, s63, v216
    v_add_f32 v217, s63, v217
    v_add_f32 v218, s63, v218
    v_add_f32 v219, s63, v219
    v_add_f32 v220, s63, v220
    v_add_f32 v221, s63, v221
    v_add_f32 v222, s63, v222
    v_add_f32 v223, s63, v223
    v_add_f32 v116, v116, v200
    v_add_f32 v117, v117, v201
    v_add_f32 v118, v118, v202
    v_add_f32 v119, v119, v203
    v_add_f32 v120, v120, v204
    v_add_f32 v121, v121, v205
    v_add_f32 v122, v122, v206
    v_add_f32 v123, v123, v207
    v_add_f32 v124, v124, v208
    v_add_f32 v125, v125, v209
    v_add_f32 v126, v126, v210
    v_add_f32 v127, v127, v211
    v_add_f32 v136, v136, v212
    v_add_f32 v137, v137, v213
    v_add_f32 v138, v138, v214
    v_add_f32 v139, v139, v215
    v_add_f32 v140, v140, v216
    v_add_f32 v141, v141, v217
    v_add_f32 v142, v142, v218
    v_add_f32 v143, v143, v219
    v_add_f32 v144, v144, v220
    v_add_f32 v145, v145, v221
    v_add_f32 v146, v146, v222
    v_add_f32 v147, v147, v223
    s_lshl_b32 s15, s12, 3
    s_lshl_b32 s64, s59, 1
    s_add_u32 s15, s15, s64
    s_mul_i32 s64, s15, 24576
    s_lshr_b32 s65, s13, 1
    s_mul_i32 s65, s65, 3072
    s_add_u32 s64, s64, s65
    s_add_u32 s64, s64, 0
    s_add_u32 s16, s10, s64
    s_addc_u32 s17, s11, 0
    s_and_b32 s17, s17, 0xffff
    s_mov_b32 s18, 0x6c00
    s_mov_b32 s19, 0x00020000
    v_lshlrev_b32 v22, 4, v1
    v_lshlrev_b32 v23, 4, v10
    s_and_b32 s15, s13, 1
    s_cmp_eq_u32 s15, 1
    s_cselect_b32 s64, 2048, 8
    s_movk_i32 s65, 1028
    s_cselect_b32 s65, 2060, s65
    v_mov_b32 v24, s64
    v_mov_b32 v25, s65
    v_cmp_eq_u32 vcc, 1, v11
    s_nop 1
    v_cndmask_b32 v24, v24, v25, vcc
    v_add_u32 v23, v23, v24
    v_cvt_pk_bf16_f32 v100, v116, v117
    v_cvt_pk_bf16_f32 v101, v118, v119
    v_cvt_pk_bf16_f32 v102, v120, v121
    v_cvt_pk_bf16_f32 v103, v122, v123
    v_cvt_pk_bf16_f32 v104, v124, v125
    v_cvt_pk_bf16_f32 v105, v126, v127
    v_and_b32 v106, 0xffff, v104
    v_lshrrev_b32 v107, 16, v104
    v_and_b32 v108, 0xffff, v105
    v_lshrrev_b32 v109, 16, v105
    v_cvt_pk_bf16_f32 v110, v136, v137
    v_cvt_pk_bf16_f32 v111, v138, v139
    v_cvt_pk_bf16_f32 v112, v140, v141
    v_cvt_pk_bf16_f32 v113, v142, v143
    v_cvt_pk_bf16_f32 v114, v144, v145
    v_cvt_pk_bf16_f32 v115, v146, v147
    v_and_b32 v116, 0xffff, v114
    v_lshrrev_b32 v117, 16, v114
    v_and_b32 v118, 0xffff, v115
    v_lshrrev_b32 v119, 16, v115
    s_cmp_eq_u32 s15, 1
    s_cbranch_scc1 k1pqo_32
    s_movk_i32 s64, 0
    buffer_store_dwordx2 v[100:101], v22, s[16:19], s64 offen
    buffer_store_dword v102, v22, s[16:19], s64 offen offset:12
    buffer_store_dword v103, v22, s[16:19], s64 offen offset:1024
    s_movk_i32 s64, 24576
    buffer_store_dwordx2 v[110:111], v22, s[16:19], s64 offen
    buffer_store_dword v112, v22, s[16:19], s64 offen offset:12
    buffer_store_dword v113, v22, s[16:19], s64 offen offset:1024
    s_branch k1pqd_33
k1pqo_32:
    s_movk_i32 s64, 0
    buffer_store_dwordx2 v[100:101], v22, s[16:19], s64 offen offset:1032
    buffer_store_dwordx2 v[102:103], v22, s[16:19], s64 offen offset:2052
    s_movk_i32 s64, 24576
    buffer_store_dwordx2 v[110:111], v22, s[16:19], s64 offen offset:1032
    buffer_store_dwordx2 v[112:113], v22, s[16:19], s64 offen offset:2052
k1pqd_33:
    s_mov_b64 exec, 0xffffffff
    s_movk_i32 s64, 0
    buffer_store_dword v106, v23, s[16:19], s64 offen offset:0
    buffer_store_dword v107, v23, s[16:19], s64 offen offset:256
    buffer_store_dword v108, v23, s[16:19], s64 offen offset:512
    buffer_store_dword v109, v23, s[16:19], s64 offen offset:768
    s_movk_i32 s64, 24576
    buffer_store_dword v116, v23, s[16:19], s64 offen offset:0
    buffer_store_dword v117, v23, s[16:19], s64 offen offset:256
    buffer_store_dword v118, v23, s[16:19], s64 offen offset:512
    buffer_store_dword v119, v23, s[16:19], s64 offen offset:768
    s_mov_b64 exec, -1
    s_branch k1_kernel_e1c
k1_kernel_e1b:
    ds_read_b128 v[36:39], v13 offset:0
    ds_read_b128 v[40:43], v13 offset:16
    ds_read_b128 v[44:47], v13 offset:128
    ds_read_b128 v[48:51], v13 offset:144
    v_lshlrev_b32 v20, 2, v10
    ds_read_b32 v76, v20 offset:1216
    ds_read_b32 v77, v20 offset:1728
    ds_read_b32 v78, v20 offset:1280
    ds_read_b32 v79, v20 offset:1792
    ds_read_b32 v80, v20 offset:1344
    ds_read_b32 v81, v20 offset:1856
    ds_read_b32 v82, v20 offset:1408
    ds_read_b32 v83, v20 offset:1920
    ds_read_b32 v84, v20 offset:1472
    ds_read_b32 v85, v20 offset:1984
    s_waitcnt lgkmcnt(0)
    v_mul_f32 v36, s60, v36
    v_mul_f32 v37, s60, v37
    v_mul_f32 v38, s60, v38
    v_mul_f32 v39, s60, v39
    v_mul_f32 v40, s60, v40
    v_mul_f32 v41, s60, v41
    v_mul_f32 v42, s60, v42
    v_mul_f32 v43, s60, v43
    v_mul_f32 v44, s60, v44
    v_mul_f32 v45, s60, v45
    v_mul_f32 v46, s60, v46
    v_mul_f32 v47, s60, v47
    v_mul_f32 v48, s60, v48
    v_mul_f32 v49, s60, v49
    v_mul_f32 v50, s60, v50
    v_mul_f32 v51, s60, v51
    v_fma_f32 v37, -v36, v36, v37
    v_fma_f32 v39, -v38, v38, v39
    v_fma_f32 v41, -v40, v40, v41
    v_fma_f32 v43, -v42, v42, v43
    v_fma_f32 v45, -v44, v44, v45
    v_fma_f32 v47, -v46, v46, v47
    v_fma_f32 v49, -v48, v48, v49
    v_fma_f32 v51, -v50, v50, v51
    v_add_f32 v37, s61, v37
    v_add_f32 v39, s61, v39
    v_add_f32 v41, s61, v41
    v_add_f32 v43, s61, v43
    v_add_f32 v45, s61, v45
    v_add_f32 v47, s61, v47
    v_add_f32 v49, s61, v49
    v_add_f32 v51, s61, v51
    v_rsq_f32 v37, v37
    v_rsq_f32 v39, v39
    v_rsq_f32 v41, v41
    v_rsq_f32 v43, v43
    v_rsq_f32 v45, v45
    v_rsq_f32 v47, v47
    v_rsq_f32 v49, v49
    v_rsq_f32 v51, v51
    v_sub_f32 v36, 0, v36
    v_sub_f32 v38, 0, v38
    v_sub_f32 v40, 0, v40
    v_sub_f32 v42, 0, v42
    v_sub_f32 v44, 0, v44
    v_sub_f32 v46, 0, v46
    v_sub_f32 v48, 0, v48
    v_sub_f32 v50, 0, v50
    v_add_f32 v76, v76, v77
    v_add_f32 v78, v78, v79
    v_add_f32 v80, v80, v81
    v_add_f32 v82, v82, v83
    v_add_f32 v84, v84, v85
    v_cmp_gt_u32 s[64:65], 8, v10
    v_fma_f32 v116, v36, v76, v116
    v_fma_f32 v117, v38, v76, v117
    v_fma_f32 v118, v40, v76, v118
    v_fma_f32 v119, v42, v76, v119
    v_fma_f32 v120, v36, v78, v120
    v_fma_f32 v121, v38, v78, v121
    v_fma_f32 v122, v40, v78, v122
    v_fma_f32 v123, v42, v78, v123
    v_fma_f32 v124, v36, v80, v124
    v_fma_f32 v125, v38, v80, v125
    v_fma_f32 v126, v40, v80, v126
    v_fma_f32 v127, v42, v80, v127
    v_fma_f32 v136, v44, v76, v136
    v_fma_f32 v137, v46, v76, v137
    v_fma_f32 v138, v48, v76, v138
    v_fma_f32 v139, v50, v76, v139
    v_fma_f32 v140, v44, v78, v140
    v_fma_f32 v141, v46, v78, v141
    v_fma_f32 v142, v48, v78, v142
    v_fma_f32 v143, v50, v78, v143
    v_fma_f32 v144, v44, v80, v144
    v_fma_f32 v145, v46, v80, v145
    v_fma_f32 v146, v48, v80, v146
    v_fma_f32 v147, v50, v80, v147
    v_fma_f32 v128, v36, v82, v128
    v_fma_f32 v129, v38, v82, v129
    v_fma_f32 v130, v40, v82, v130
    v_fma_f32 v131, v42, v82, v131
    v_fma_f32 v132, v36, v84, v132
    v_fma_f32 v133, v38, v84, v133
    v_fma_f32 v134, v40, v84, v134
    v_fma_f32 v135, v42, v84, v135
    v_fma_f32 v148, v44, v82, v148
    v_fma_f32 v149, v46, v82, v149
    v_fma_f32 v150, v48, v82, v150
    v_fma_f32 v151, v50, v82, v151
    v_fma_f32 v152, v44, v84, v152
    v_fma_f32 v153, v46, v84, v153
    v_fma_f32 v154, v48, v84, v154
    v_fma_f32 v155, v50, v84, v155
    v_mul_f32 v116, v116, v37
    v_mul_f32 v117, v117, v39
    v_mul_f32 v118, v118, v41
    v_mul_f32 v119, v119, v43
    v_mul_f32 v120, v120, v37
    v_mul_f32 v121, v121, v39
    v_mul_f32 v122, v122, v41
    v_mul_f32 v123, v123, v43
    v_mul_f32 v124, v124, v37
    v_mul_f32 v125, v125, v39
    v_mul_f32 v126, v126, v41
    v_mul_f32 v127, v127, v43
    v_mul_f32 v136, v136, v45
    v_mul_f32 v137, v137, v47
    v_mul_f32 v138, v138, v49
    v_mul_f32 v139, v139, v51
    v_mul_f32 v140, v140, v45
    v_mul_f32 v141, v141, v47
    v_mul_f32 v142, v142, v49
    v_mul_f32 v143, v143, v51
    v_mul_f32 v144, v144, v45
    v_mul_f32 v145, v145, v47
    v_mul_f32 v146, v146, v49
    v_mul_f32 v147, v147, v51
    v_mul_f32 v128, v128, v37
    v_mul_f32 v129, v129, v39
    v_mul_f32 v130, v130, v41
    v_mul_f32 v131, v131, v43
    v_mul_f32 v132, v132, v37
    v_mul_f32 v133, v133, v39
    v_mul_f32 v134, v134, v41
    v_mul_f32 v135, v135, v43
    v_mul_f32 v148, v148, v45
    v_mul_f32 v149, v149, v47
    v_mul_f32 v150, v150, v49
    v_mul_f32 v151, v151, v51
    v_mul_f32 v152, v152, v45
    v_mul_f32 v153, v153, v47
    v_mul_f32 v154, v154, v49
    v_mul_f32 v155, v155, v51
    v_mov_b32 v224, v124
    v_mov_b32 v225, v125
    v_mov_b32 v226, v126
    v_mov_b32 v227, v127
    v_mov_b32 v228, v144
    v_mov_b32 v229, v145
    v_mov_b32 v230, v146
    v_mov_b32 v231, v147
    v_mul_f32 v200, s62, v116
    v_mul_f32 v201, s62, v117
    v_mul_f32 v202, s62, v118
    v_mul_f32 v203, s62, v119
    v_mul_f32 v204, s62, v120
    v_mul_f32 v205, s62, v121
    v_mul_f32 v206, s62, v122
    v_mul_f32 v207, s62, v123
    v_mul_f32 v208, s62, v124
    v_mul_f32 v209, s62, v125
    v_mul_f32 v210, s62, v126
    v_mul_f32 v211, s62, v127
    v_mul_f32 v212, s62, v136
    v_mul_f32 v213, s62, v137
    v_mul_f32 v214, s62, v138
    v_mul_f32 v215, s62, v139
    v_mul_f32 v216, s62, v140
    v_mul_f32 v217, s62, v141
    v_mul_f32 v218, s62, v142
    v_mul_f32 v219, s62, v143
    v_mul_f32 v220, s62, v144
    v_mul_f32 v221, s62, v145
    v_mul_f32 v222, s62, v146
    v_mul_f32 v223, s62, v147
    v_exp_f32 v200, v200 clamp
    v_exp_f32 v201, v201 clamp
    v_exp_f32 v202, v202 clamp
    v_exp_f32 v203, v203 clamp
    v_exp_f32 v204, v204 clamp
    v_exp_f32 v205, v205 clamp
    v_exp_f32 v206, v206 clamp
    v_exp_f32 v207, v207 clamp
    v_exp_f32 v208, v208 clamp
    v_exp_f32 v209, v209 clamp
    v_exp_f32 v210, v210 clamp
    v_exp_f32 v211, v211 clamp
    v_exp_f32 v212, v212 clamp
    v_exp_f32 v213, v213 clamp
    v_exp_f32 v214, v214 clamp
    v_exp_f32 v215, v215 clamp
    v_exp_f32 v216, v216 clamp
    v_exp_f32 v217, v217 clamp
    v_exp_f32 v218, v218 clamp
    v_exp_f32 v219, v219 clamp
    v_exp_f32 v220, v220 clamp
    v_exp_f32 v221, v221 clamp
    v_exp_f32 v222, v222 clamp
    v_exp_f32 v223, v223 clamp
    v_max_f32 v116, 0, v116
    v_max_f32 v117, 0, v117
    v_max_f32 v118, 0, v118
    v_max_f32 v119, 0, v119
    v_max_f32 v120, 0, v120
    v_max_f32 v121, 0, v121
    v_max_f32 v122, 0, v122
    v_max_f32 v123, 0, v123
    v_max_f32 v124, 0, v124
    v_max_f32 v125, 0, v125
    v_max_f32 v126, 0, v126
    v_max_f32 v127, 0, v127
    v_max_f32 v136, 0, v136
    v_max_f32 v137, 0, v137
    v_max_f32 v138, 0, v138
    v_max_f32 v139, 0, v139
    v_max_f32 v140, 0, v140
    v_max_f32 v141, 0, v141
    v_max_f32 v142, 0, v142
    v_max_f32 v143, 0, v143
    v_max_f32 v144, 0, v144
    v_max_f32 v145, 0, v145
    v_max_f32 v146, 0, v146
    v_max_f32 v147, 0, v147
    v_add_f32 v200, s63, v200
    v_add_f32 v201, s63, v201
    v_add_f32 v202, s63, v202
    v_add_f32 v203, s63, v203
    v_add_f32 v204, s63, v204
    v_add_f32 v205, s63, v205
    v_add_f32 v206, s63, v206
    v_add_f32 v207, s63, v207
    v_add_f32 v208, s63, v208
    v_add_f32 v209, s63, v209
    v_add_f32 v210, s63, v210
    v_add_f32 v211, s63, v211
    v_add_f32 v212, s63, v212
    v_add_f32 v213, s63, v213
    v_add_f32 v214, s63, v214
    v_add_f32 v215, s63, v215
    v_add_f32 v216, s63, v216
    v_add_f32 v217, s63, v217
    v_add_f32 v218, s63, v218
    v_add_f32 v219, s63, v219
    v_add_f32 v220, s63, v220
    v_add_f32 v221, s63, v221
    v_add_f32 v222, s63, v222
    v_add_f32 v223, s63, v223
    v_add_f32 v116, v116, v200
    v_add_f32 v117, v117, v201
    v_add_f32 v118, v118, v202
    v_add_f32 v119, v119, v203
    v_add_f32 v120, v120, v204
    v_add_f32 v121, v121, v205
    v_add_f32 v122, v122, v206
    v_add_f32 v123, v123, v207
    v_add_f32 v124, v124, v208
    v_add_f32 v125, v125, v209
    v_add_f32 v126, v126, v210
    v_add_f32 v127, v127, v211
    v_add_f32 v136, v136, v212
    v_add_f32 v137, v137, v213
    v_add_f32 v138, v138, v214
    v_add_f32 v139, v139, v215
    v_add_f32 v140, v140, v216
    v_add_f32 v141, v141, v217
    v_add_f32 v142, v142, v218
    v_add_f32 v143, v143, v219
    v_add_f32 v144, v144, v220
    v_add_f32 v145, v145, v221
    v_add_f32 v146, v146, v222
    v_add_f32 v147, v147, v223
    v_cndmask_b32 v124, v224, v124, s[64:65]
    v_cndmask_b32 v125, v225, v125, s[64:65]
    v_cndmask_b32 v126, v226, v126, s[64:65]
    v_cndmask_b32 v127, v227, v127, s[64:65]
    v_cndmask_b32 v144, v228, v144, s[64:65]
    v_cndmask_b32 v145, v229, v145, s[64:65]
    v_cndmask_b32 v146, v230, v146, s[64:65]
    v_cndmask_b32 v147, v231, v147, s[64:65]
    v_cvt_pk_bf16_f32 v88, v116, v117
    v_cvt_pk_bf16_f32 v89, v118, v119
    v_cvt_pk_bf16_f32 v90, v136, v137
    v_cvt_pk_bf16_f32 v91, v138, v139
    v_cvt_pk_bf16_f32 v92, v120, v121
    v_cvt_pk_bf16_f32 v93, v122, v123
    v_cvt_pk_bf16_f32 v94, v140, v141
    v_cvt_pk_bf16_f32 v95, v142, v143
    v_cvt_pk_bf16_f32 v96, v124, v125
    v_cvt_pk_bf16_f32 v97, v126, v127
    v_cvt_pk_bf16_f32 v98, v144, v145
    v_cvt_pk_bf16_f32 v99, v146, v147
    v_cvt_pk_bf16_f32 v100, v128, v129
    v_cvt_pk_bf16_f32 v101, v130, v131
    v_cvt_pk_bf16_f32 v102, v148, v149
    v_cvt_pk_bf16_f32 v103, v150, v151
    v_cvt_pk_bf16_f32 v104, v132, v133
    v_cvt_pk_bf16_f32 v105, v134, v135
    v_cvt_pk_bf16_f32 v106, v152, v153
    v_cvt_pk_bf16_f32 v107, v154, v155
    s_nop 1
    v_mfma_f32_16x16x32_bf16 v[116:119], v[100:103], v[88:91], 0
    v_mfma_f32_16x16x32_bf16 v[120:123], v[100:103], v[92:95], 0
    v_mfma_f32_16x16x32_bf16 v[124:127], v[104:107], v[88:91], 0
    v_mfma_f32_16x16x32_bf16 v[128:131], v[104:107], v[92:95], 0
    v_mfma_f32_16x16x32_bf16 v[132:135], v[104:107], v[96:99], 0
    v_mfma_f32_16x16x32_bf16 v[136:139], v[96:99], v[92:95], 0
    v_mfma_f32_16x16x32_bf16 v[140:143], v[96:99], v[96:99], 0
    v_mfma_f32_16x16x32_bf16 v[144:147], v[32:35], v[88:91], 0
    v_mfma_f32_16x16x32_bf16 v[148:151], v[32:35], v[92:95], 0
    v_mfma_f32_16x16x32_bf16 v[152:155], v[32:35], v[96:99], 0
    v_mul_u32_u24 v24, 768, v11
    v_lshl_add_u32 v24, v10, 2, v24
    s_mul_i32 s15, s59, 9472
    s_add_u32 s15, s15, 4096
    v_add_u32 v24, s15, v24
    s_nop 7
    ds_write_b32 v24, v116 offset:0
    ds_write_b32 v24, v117 offset:192
    ds_write_b32 v24, v118 offset:384
    ds_write_b32 v24, v119 offset:576
    ds_write_b32 v24, v120 offset:64
    ds_write_b32 v24, v121 offset:256
    ds_write_b32 v24, v122 offset:448
    ds_write_b32 v24, v123 offset:640
    ds_write_b32 v24, v124 offset:3072
    ds_write_b32 v24, v125 offset:3264
    ds_write_b32 v24, v126 offset:3456
    ds_write_b32 v24, v127 offset:3648
    ds_write_b32 v24, v128 offset:3136
    ds_write_b32 v24, v129 offset:3328
    ds_write_b32 v24, v130 offset:3520
    ds_write_b32 v24, v131 offset:3712
    ds_write_b32 v24, v132 offset:3200
    ds_write_b32 v24, v133 offset:3392
    ds_write_b32 v24, v134 offset:3584
    ds_write_b32 v24, v135 offset:3776
    ds_write_b32 v24, v136 offset:6208
    ds_write_b32 v24, v137 offset:6400
    ds_write_b32 v24, v138 offset:6592
    ds_write_b32 v24, v139 offset:6784
    ds_write_b32 v24, v140 offset:6272
    ds_write_b32 v24, v141 offset:6464
    ds_write_b32 v24, v142 offset:6656
    ds_write_b32 v24, v143 offset:6848
    s_mov_b64 exec, 0xffff
    ds_write_b32 v24, v144 offset:9216
    ds_write_b32 v24, v148 offset:9280
    ds_write_b32 v24, v152 offset:9344
    s_mov_b64 exec, -1
k1_kernel_e1c:
    s_waitcnt lgkmcnt(0)
    s_barrier
    v_add_u32 v36, 0, v0
    v_cmp_lt_u32 vcc, 479, v36
    v_subrev_u32 v41, 480, v36
    v_mov_b32 v38, 0
    v_cndmask_b32 v37, v36, v41, vcc
    v_cndmask_b32 v38, 0, 1, vcc
    v_bfe_u32 v39, v37, 2, 4
    v_lshrrev_b32 v41, 6, v37
    v_and_b32 v42, 3, v37
    v_lshl_add_u32 v40, v41, 2, v42
    v_cmp_lt_u32 vcc, 255, v37
    v_and_b32 v41, 15, v37
    v_bfe_u32 v42, v37, 4, 2
    v_add_u32 v42, 16, v42
    v_cndmask_b32 v39, v39, v41, vcc
    v_cndmask_b32 v40, v40, v42, vcc
    v_subrev_u32 v43, 320, v37
    v_bfe_u32 v44, v43, 2, 3
    v_lshrrev_b32 v45, 5, v43
    v_and_b32 v46, 3, v43
    v_lshl_add_u32 v45, v45, 2, v46
    s_movk_i32 s57, 447
    v_cmp_lt_u32 s[60:61], s57, v37
    v_and_b32 v46, 7, v37
    v_bfe_u32 v47, v37, 3, 2
    v_add_u32 v47, 16, v47
    v_cmp_lt_u32 vcc, 319, v37
    v_cndmask_b32 v44, v44, v46, s[60:61]
    v_cndmask_b32 v45, v45, v47, s[60:61]
    v_lshrrev_b32 v46, 1, v44
    v_add_u32 v46, 16, v46
    v_and_b32 v47, 1, v44
    v_cmp_eq_u32 s[60:61], 1, v47
    v_mov_b32 v49, v39
    v_cndmask_b32 v39, v39, v46, vcc
    v_cndmask_b32 v40, v40, v45, vcc
    s_and_b64 s[60:61], s[60:61], vcc
    v_lshlrev_b32 v52, 2, v37
    v_lshl_add_u32 v52, v38, 11, v52
    v_mul_u32_u24 v46, 20, v38
    v_add_u32 v39, v39, v46
    v_add_u32 v40, v40, v46
    v_add_u32 v47, 8, v39
    v_cmp_lt_u32 vcc, 31, v39
    v_mov_b32 v46, 48
    s_nop 0
    v_cndmask_b32 v39, v39, v47, vcc
    v_cndmask_b32 v39, v39, v46, s[60:61]
    v_mul_u32_u24 v39, 48, v39
    v_add_lshl_u32 v39, v39, v40, 2
    ds_read_b32 v60, v39 offset:4096
    ds_read_b32 v61, v39 offset:13568
    ds_read_b32 v62, v39 offset:23040
    ds_read_b32 v63, v39 offset:32512
    v_add_u32 v36, 512, v0
    v_cmp_lt_u32 vcc, 479, v36
    v_subrev_u32 v41, 480, v36
    v_mov_b32 v38, 0
    v_cndmask_b32 v37, v36, v41, vcc
    v_cndmask_b32 v38, 0, 1, vcc
    v_bfe_u32 v39, v37, 2, 4
    v_lshrrev_b32 v41, 6, v37
    v_and_b32 v42, 3, v37
    v_lshl_add_u32 v40, v41, 2, v42
    v_cmp_lt_u32 vcc, 255, v37
    v_and_b32 v41, 15, v37
    v_bfe_u32 v42, v37, 4, 2
    v_add_u32 v42, 16, v42
    v_cndmask_b32 v39, v39, v41, vcc
    v_cndmask_b32 v40, v40, v42, vcc
    v_subrev_u32 v43, 320, v37
    v_bfe_u32 v44, v43, 2, 3
    v_lshrrev_b32 v45, 5, v43
    v_and_b32 v46, 3, v43
    v_lshl_add_u32 v45, v45, 2, v46
    s_movk_i32 s57, 447
    v_cmp_lt_u32 s[60:61], s57, v37
    v_and_b32 v46, 7, v37
    v_bfe_u32 v47, v37, 3, 2
    v_add_u32 v47, 16, v47
    v_cmp_lt_u32 vcc, 319, v37
    v_cndmask_b32 v44, v44, v46, s[60:61]
    v_cndmask_b32 v45, v45, v47, s[60:61]
    v_lshrrev_b32 v46, 1, v44
    v_add_u32 v46, 16, v46
    v_and_b32 v47, 1, v44
    v_cmp_eq_u32 s[60:61], 1, v47
    v_mov_b32 v49, v39
    v_cndmask_b32 v39, v39, v46, vcc
    v_cndmask_b32 v40, v40, v45, vcc
    s_and_b64 s[60:61], s[60:61], vcc
    v_lshlrev_b32 v53, 2, v37
    v_lshl_add_u32 v53, v38, 11, v53
    v_mul_u32_u24 v46, 20, v38
    v_add_u32 v39, v39, v46
    v_add_u32 v40, v40, v46
    v_add_u32 v47, 8, v39
    v_cmp_lt_u32 vcc, 31, v39
    v_mov_b32 v46, 48
    s_nop 0
    v_cndmask_b32 v39, v39, v47, vcc
    v_cndmask_b32 v39, v39, v46, s[60:61]
    v_mul_u32_u24 v39, 48, v39
    v_add_lshl_u32 v39, v39, v40, 2
    ds_read_b32 v68, v39 offset:4096
    ds_read_b32 v69, v39 offset:13568
    ds_read_b32 v70, v39 offset:23040
    ds_read_b32 v71, v39 offset:32512
    s_waitcnt lgkmcnt(0)
    v_add_f32 v60, v60, v61
    v_add_f32 v62, v62, v63
    v_add_f32 v60, v60, v62
    v_mov_b32 v50, v60
    v_add_f32 v68, v68, v69
    v_add_f32 v70, v70, v71
    v_add_f32 v68, v68, v70
    v_mov_b32 v51, v68
k1_kernel_poll:
    s_waitcnt vmcnt(0)
    v_readfirstlane_b32 s15, v31
    s_cmp_eq_u32 s15, 0
    s_cbranch_scc0 k1_kernel_go
    s_sleep 2
    buffer_load_dword v31, v30, s[28:31], 0 offen sc1
    s_branch k1_kernel_poll
k1_kernel_go:
    buffer_atomic_add_f32 v50, v52, s[24:27], 0 offen
    v_cmp_gt_u32 vcc, 448, v0
    s_nop 1
    s_and_saveexec_b64 s[62:63], vcc
    s_cbranch_execz k1_kernel_na
    buffer_atomic_add_f32 v51, v53, s[24:27], 0 offen
k1_kernel_na:
    s_mov_b64 exec, -1
k1_kernel_end:
    s_endpgm
.globl k2_kernel
.p2align 8
.type k2_kernel,@function
k2_kernel:
    s_cmp_ge_u32 s2, 256
    s_cbranch_scc1 k2_kernel_end
    s_cmp_ge_u32 s2, 16
    s_cbranch_scc1 pcq_36
    s_getpc_b64 s[94:95]
pc_34:
    s_add_u32 s94, s94, (k2_kernel-pc_34)&0xffffffff
    s_addc_u32 s95, s95, ((k2_kernel-pc_34)>>32)&0xffffffff
    v_lshlrev_b32 v250, 7, v0
    s_mov_b32 s96, k4_kernel_end-k2_kernel
    v_cmp_gt_u32 vcc, s96, v250
    s_and_saveexec_b64 s[98:99], vcc
    s_cbranch_execz pcs_35
    global_load_dword v251, v250, s[94:95] offset:0
pcs_35:
    s_mov_b64 exec, s[98:99]
pcq_36:
    s_load_dwordx2 s[4:5], s[0:1], 0
    s_load_dwordx2 s[10:11], s[0:1], 64
    v_and_b32 v1, 63, v0
    v_lshrrev_b32 v4, 6, v0
    s_and_b32 s15, s2, 7
    s_lshr_b32 s13, s2, 3
    v_readfirstlane_b32 s14, v4
    s_lshr_b32 s12, s13, 2
    s_lshr_b32 s16, s15, 1
    s_lshl_b32 s16, s16, 3
    s_add_u32 s12, s12, s16
    s_and_b32 s13, s13, 3
    s_and_b32 s15, s15, 1
    s_lshl_b32 s15, s15, 2
    s_add_u32 s13, s13, s15
    v_and_b32 v2, 15, v1
    v_lshrrev_b32 v3, 4, v1
    v_lshlrev_b32 v4, 4, v1
    v_lshlrev_b32 v5, 3, v1
    v_lshlrev_b32 v6, 2, v1
    s_waitcnt lgkmcnt(0)
    s_lshl_b32 s15, s14, 14
    s_add_u32 s15, s15, 3145728
    s_add_u32 s16, s10, s15
    s_addc_u32 s17, s11, 0
    s_and_b32 s17, s17, 0xffff
    s_mov_b32 s18, 0x4000
    s_mov_b32 s19, 0x00020000
    v_lshlrev_b32 v6, 2, v1
    v_lshrrev_b32 v7, 2, v2
    v_and_b32 v8, 1, v2
    v_lshl_add_u32 v7, v7, 1, v8
    v_lshlrev_b32 v8, 7, v3
    v_lshl_add_u32 v8, v7, 4, v8
    v_lshlrev_b32 v9, 5, v3
    v_lshl_add_u32 v9, v7, 2, v9
    v_and_b32 v7, 3, v2
    v_cmp_gt_u32 s[40:41], 2, v7
    v_mov_b32 v116, 0
    v_mov_b32 v117, 0
    v_mov_b32 v118, 0
    v_mov_b32 v119, 0
    v_mov_b32 v121, 0
    v_mov_b32 v126, 0
    v_mov_b32 v127, 0
    v_mov_b32 v128, 0
    v_mov_b32 v129, 0
    v_mov_b32 v131, 0
    v_mov_b32 v136, 0
    v_mov_b32 v137, 0
    v_mov_b32 v138, 0
    v_mov_b32 v139, 0
    v_mov_b32 v141, 0
    v_mov_b32 v146, 0
    v_mov_b32 v147, 0
    v_mov_b32 v148, 0
    v_mov_b32 v149, 0
    v_mov_b32 v151, 0
    v_accvgpr_write_b32 a184, 0
    v_accvgpr_write_b32 a185, 0
    v_accvgpr_write_b32 a186, 0
    v_accvgpr_write_b32 a187, 0
    v_accvgpr_write_b32 a189, 0
    v_accvgpr_write_b32 a194, 0
    v_accvgpr_write_b32 a195, 0
    v_accvgpr_write_b32 a196, 0
    v_accvgpr_write_b32 a197, 0
    v_accvgpr_write_b32 a199, 0
    v_accvgpr_write_b32 a204, 0
    v_accvgpr_write_b32 a205, 0
    v_accvgpr_write_b32 a206, 0
    v_accvgpr_write_b32 a207, 0
    v_accvgpr_write_b32 a209, 0
    v_accvgpr_write_b32 a214, 0
    v_accvgpr_write_b32 a215, 0
    v_accvgpr_write_b32 a216, 0
    v_accvgpr_write_b32 a217, 0
    v_accvgpr_write_b32 a219, 0
    s_mul_i32 s15, s12, 98304
    s_mul_i32 s44, s14, 6144
    s_add_u32 s15, s15, s44
    s_add_u32 s15, s15, 0
    s_add_u32 s20, s10, s15
    s_addc_u32 s21, s11, 0
    s_and_b32 s21, s21, 0xffff
    s_mov_b32 s22, 0x13800
    s_mov_b32 s23, 0x00020000
    s_lshl_b32 s15, s13, 2
    s_add_u32 s15, s15, s14
    s_mul_i32 s15, s15, 25600
    s_add_u32 s15, s15, 16777216
    s_add_u32 s28, s10, s15
    s_addc_u32 s29, s11, 0
    s_and_b32 s29, s29, 0xffff
    s_mov_b32 s30, 0x6400
    s_mov_b32 s31, 0x00020000
    s_mul_i32 s15, s12, 81920
    s_add_u32 s32, s4, s15
    s_addc_u32 s33, s5, 0
    s_and_b32 s33, s33, 0xffff
    s_mov_b32 s34, 0x14000
    s_mov_b32 s35, 0x00020000
    s_lshl_b32 s15, s14, 4
    v_add_u32 v7, s15, v2
    s_movk_i32 s15, 1280
    v_mul_lo_u32 v7, v7, s15
    s_mul_i32 s15, s13, 160
    v_lshl_add_u32 v7, v3, 3, v7
    v_add_u32 v7, s15, v7
    s_movk_i32 s15, 0
    buffer_load_dwordx4 v[112:115], v4, s[16:19], s15 offen
    buffer_load_dword v120, v6, s[16:19], s15 offen offset:1024
    s_mov_b64 exec, s[40:41]
    buffer_load_dwordx4 v[116:119], v8, s[16:19], s15 offen offset:1280
    buffer_load_dword v121, v9, s[16:19], s15 offen offset:1792
    s_mov_b64 exec, -1
    s_movk_i32 s15, 2048
    buffer_load_dwordx4 v[122:125], v4, s[16:19], s15 offen
    buffer_load_dword v130, v6, s[16:19], s15 offen offset:1024
    s_mov_b64 exec, s[40:41]
    buffer_load_dwordx4 v[126:129], v8, s[16:19], s15 offen offset:1280
    buffer_load_dword v131, v9, s[16:19], s15 offen offset:1792
    s_mov_b64 exec, -1
    s_movk_i32 s15, 4096
    buffer_load_dwordx4 v[132:135], v4, s[16:19], s15 offen
    buffer_load_dword v140, v6, s[16:19], s15 offen offset:1024
    s_mov_b64 exec, s[40:41]
    buffer_load_dwordx4 v[136:139], v8, s[16:19], s15 offen offset:1280
    buffer_load_dword v141, v9, s[16:19], s15 offen offset:1792
    s_mov_b64 exec, -1
    s_movk_i32 s15, 6144
    buffer_load_dwordx4 v[142:145], v4, s[16:19], s15 offen
    buffer_load_dword v150, v6, s[16:19], s15 offen offset:1024
    s_mov_b64 exec, s[40:41]
    buffer_load_dwordx4 v[146:149], v8, s[16:19], s15 offen offset:1280
    buffer_load_dword v151, v9, s[16:19], s15 offen offset:1792
    s_mov_b64 exec, -1
    s_movk_i32 s15, 8192
    buffer_load_dwordx4 a[180:183], v4, s[16:19], s15 offen
    buffer_load_dword a188, v6, s[16:19], s15 offen offset:1024
    s_mov_b64 exec, s[40:41]
    buffer_load_dwordx4 a[184:187], v8, s[16:19], s15 offen offset:1280
    buffer_load_dword a189, v9, s[16:19], s15 offen offset:1792
    s_mov_b64 exec, -1
    s_movk_i32 s15, 10240
    buffer_load_dwordx4 a[190:193], v4, s[16:19], s15 offen
    buffer_load_dword a198, v6, s[16:19], s15 offen offset:1024
    s_mov_b64 exec, s[40:41]
    buffer_load_dwordx4 a[194:197], v8, s[16:19], s15 offen offset:1280
    buffer_load_dword a199, v9, s[16:19], s15 offen offset:1792
    s_mov_b64 exec, -1
    s_movk_i32 s15, 12288
    buffer_load_dwordx4 a[200:203], v4, s[16:19], s15 offen
    buffer_load_dword a208, v6, s[16:19], s15 offen offset:1024
    s_mov_b64 exec, s[40:41]
    buffer_load_dwordx4 a[204:207], v8, s[16:19], s15 offen offset:1280
    buffer_load_dword a209, v9, s[16:19], s15 offen offset:1792
    s_mov_b64 exec, -1
    s_movk_i32 s15, 14336
    buffer_load_dwordx4 a[210:213], v4, s[16:19], s15 offen
    buffer_load_dword a218, v6, s[16:19], s15 offen offset:1024
    s_mov_b64 exec, s[40:41]
    buffer_load_dwordx4 a[214:217], v8, s[16:19], s15 offen offset:1280
    buffer_load_dword a219, v9, s[16:19], s15 offen offset:1792
    s_mov_b64 exec, -1
    s_mov_b32 s42, 0
    buffer_load_dwordx4 v[16:19], v4, s[20:23], s42 offen offset:0
    s_mov_b32 s42, 0
    buffer_load_dwordx4 v[20:23], v4, s[20:23], s42 offen offset:1024
    s_mov_b32 s42, 0
    buffer_load_dwordx4 v[24:27], v4, s[20:23], s42 offen offset:2048
    s_mov_b32 s42, 0
    buffer_load_dwordx4 v[28:31], v4, s[20:23], s42 offen offset:3072
    s_mov_b32 s42, 4096
    buffer_load_dwordx4 v[32:35], v4, s[20:23], s42 offen offset:0
    s_mov_b32 s42, 4096
    buffer_load_dwordx4 v[36:39], v4, s[20:23], s42 offen offset:1024
    v_accvgpr_write_b32 a100, 0
    v_accvgpr_write_b32 a101, 0
    v_accvgpr_write_b32 a102, 0
    v_accvgpr_write_b32 a103, 0
    v_accvgpr_write_b32 a104, 0
    v_accvgpr_write_b32 a105, 0
    v_accvgpr_write_b32 a106, 0
    v_accvgpr_write_b32 a107, 0
    v_accvgpr_write_b32 a108, 0
    v_accvgpr_write_b32 a109, 0
    v_accvgpr_write_b32 a110, 0
    v_accvgpr_write_b32 a111, 0
    v_accvgpr_write_b32 a112, 0
    v_accvgpr_write_b32 a113, 0
    v_accvgpr_write_b32 a114, 0
    v_accvgpr_write_b32 a115, 0
    v_accvgpr_write_b32 a116, 0
    v_accvgpr_write_b32 a117, 0
    v_accvgpr_write_b32 a118, 0
    v_accvgpr_write_b32 a119, 0
    v_accvgpr_write_b32 a120, 0
    v_accvgpr_write_b32 a121, 0
    v_accvgpr_write_b32 a122, 0
    v_accvgpr_write_b32 a123, 0
    v_accvgpr_write_b32 a124, 0
    v_accvgpr_write_b32 a125, 0
    v_accvgpr_write_b32 a126, 0
    v_accvgpr_write_b32 a127, 0
    v_accvgpr_write_b32 a128, 0
    v_accvgpr_write_b32 a129, 0
    v_accvgpr_write_b32 a130, 0
    v_accvgpr_write_b32 a131, 0
    v_accvgpr_write_b32 a132, 0
    v_accvgpr_write_b32 a133, 0
    v_accvgpr_write_b32 a134, 0
    v_accvgpr_write_b32 a135, 0
    v_accvgpr_write_b32 a136, 0
    v_accvgpr_write_b32 a137, 0
    v_accvgpr_write_b32 a138, 0
    v_accvgpr_write_b32 a139, 0
    v_accvgpr_write_b32 a140, 0
    v_accvgpr_write_b32 a141, 0
    v_accvgpr_write_b32 a142, 0
    v_accvgpr_write_b32 a143, 0
    v_accvgpr_write_b32 a144, 0
    v_accvgpr_write_b32 a145, 0
    v_accvgpr_write_b32 a146, 0
    v_accvgpr_write_b32 a147, 0
    v_accvgpr_write_b32 a148, 0
    v_accvgpr_write_b32 a149, 0
    v_accvgpr_write_b32 a150, 0
    v_accvgpr_write_b32 a151, 0
    v_accvgpr_write_b32 a152, 0
    v_accvgpr_write_b32 a153, 0
    v_accvgpr_write_b32 a154, 0
    v_accvgpr_write_b32 a155, 0
    v_accvgpr_write_b32 a156, 0
    v_accvgpr_write_b32 a157, 0
    v_accvgpr_write_b32 a158, 0
    v_accvgpr_write_b32 a159, 0
    v_accvgpr_write_b32 a160, 0
    v_accvgpr_write_b32 a161, 0
    v_accvgpr_write_b32 a162, 0
    v_accvgpr_write_b32 a163, 0
    v_accvgpr_write_b32 a164, 0
    v_accvgpr_write_b32 a165, 0
    v_accvgpr_write_b32 a166, 0
    v_accvgpr_write_b32 a167, 0
    v_accvgpr_write_b32 a168, 0
    v_accvgpr_write_b32 a169, 0
    v_accvgpr_write_b32 a170, 0
    v_accvgpr_write_b32 a171, 0
    v_accvgpr_write_b32 a172, 0
    v_accvgpr_write_b32 a173, 0
    v_accvgpr_write_b32 a174, 0
    v_accvgpr_write_b32 a175, 0
    v_accvgpr_write_b32 a176, 0
    v_accvgpr_write_b32 a177, 0
    v_accvgpr_write_b32 a178, 0
    v_accvgpr_write_b32 a179, 0
    s_waitcnt vmcnt(30)
    v_cvt_pk_bf16_f32 v160, v112, v113
    v_cvt_pk_bf16_f32 v161, v114, v115
    v_cvt_pk_bf16_f32 v162, v120, 0
    v_mov_b32 v163, 0
    v_cvt_pk_bf16_f32 v164, v116, v117
    v_cvt_pk_bf16_f32 v165, v118, v119
    s_movk_i32 s43, 0
    buffer_load_dwordx4 a[0:3], v4, s[28:31], s43 offen offset:0
    v_cvt_pk_bf16_f32 v166, v121, 0
    v_mov_b32 v167, 0
    v_cvt_pk_bf16_f32 v169, v122, v123
    v_cvt_pk_bf16_f32 v170, v124, v125
    v_cvt_pk_bf16_f32 v171, v130, 0
    v_mov_b32 v168, 0
    buffer_load_dwordx4 a[4:7], v4, s[28:31], s43 offen offset:1024
    v_cvt_pk_bf16_f32 v173, v126, v127
    v_cvt_pk_bf16_f32 v174, v128, v129
    v_cvt_pk_bf16_f32 v175, v131, 0
    v_mov_b32 v172, 0
    s_waitcnt vmcnt(24)
    v_cvt_pk_bf16_f32 v176, v132, v133
    v_cvt_pk_bf16_f32 v177, v134, v135
    buffer_load_dwordx4 a[8:11], v4, s[28:31], s43 offen offset:2048
    v_cvt_pk_bf16_f32 v178, v140, 0
    v_mov_b32 v179, 0
    v_cvt_pk_bf16_f32 v180, v136, v137
    v_cvt_pk_bf16_f32 v181, v138, v139
    v_cvt_pk_bf16_f32 v182, v141, 0
    v_mov_b32 v183, 0
    buffer_load_dwordx4 a[12:15], v4, s[28:31], s43 offen offset:3072
    v_cvt_pk_bf16_f32 v185, v142, v143
    v_cvt_pk_bf16_f32 v186, v144, v145
    v_cvt_pk_bf16_f32 v187, v150, 0
    v_mov_b32 v184, 0
    v_cvt_pk_bf16_f32 v189, v146, v147
    v_cvt_pk_bf16_f32 v190, v148, v149
    s_movk_i32 s43, 4096
    buffer_load_dwordx4 a[16:19], v4, s[28:31], s43 offen offset:0
    v_cvt_pk_bf16_f32 v191, v151, 0
    v_mov_b32 v188, 0
    s_waitcnt vmcnt(19)
    v_accvgpr_read_b32 v224, a180
    v_accvgpr_read_b32 v225, a181
    v_accvgpr_read_b32 v226, a182
    v_accvgpr_read_b32 v227, a183
    buffer_load_dwordx4 a[20:23], v4, s[28:31], s43 offen offset:1024
    v_accvgpr_read_b32 v228, a184
    v_accvgpr_read_b32 v229, a185
    v_accvgpr_read_b32 v230, a186
    v_accvgpr_read_b32 v231, a187
    v_accvgpr_read_b32 v232, a188
    v_accvgpr_read_b32 v233, a189
    buffer_load_dwordx4 a[24:27], v4, s[28:31], s43 offen offset:2048
    v_accvgpr_read_b32 v234, a190
    v_accvgpr_read_b32 v235, a191
    v_accvgpr_read_b32 v236, a192
    v_accvgpr_read_b32 v237, a193
    v_accvgpr_read_b32 v238, a194
    v_accvgpr_read_b32 v239, a195
    buffer_load_dwordx4 a[28:31], v4, s[28:31], s43 offen offset:3072
    v_accvgpr_read_b32 v240, a196
    v_accvgpr_read_b32 v241, a197
    v_accvgpr_read_b32 v242, a198
    v_accvgpr_read_b32 v243, a199
    v_cvt_pk_bf16_f32 v192, v224, v225
    v_cvt_pk_bf16_f32 v193, v226, v227
    s_movk_i32 s43, 8192
    buffer_load_dwordx4 a[32:35], v4, s[28:31], s43 offen offset:0
    v_cvt_pk_bf16_f32 v194, v232, 0
    v_mov_b32 v195, 0
    v_cvt_pk_bf16_f32 v196, v228, v229
    v_cvt_pk_bf16_f32 v197, v230, v231
    v_cvt_pk_bf16_f32 v198, v233, 0
    v_mov_b32 v199, 0
    buffer_load_dwordx4 a[36:39], v4, s[28:31], s43 offen offset:1024
    v_cvt_pk_bf16_f32 v201, v234, v235
    v_cvt_pk_bf16_f32 v202, v236, v237
    v_cvt_pk_bf16_f32 v203, v242, 0
    v_mov_b32 v200, 0
    v_cvt_pk_bf16_f32 v205, v238, v239
    v_cvt_pk_bf16_f32 v206, v240, v241
    buffer_load_dwordx4 a[40:43], v4, s[28:31], s43 offen offset:2048
    v_cvt_pk_bf16_f32 v207, v243, 0
    v_mov_b32 v204, 0
    s_waitcnt vmcnt(17)
    v_accvgpr_read_b32 v224, a200
    v_accvgpr_read_b32 v225, a201
    v_accvgpr_read_b32 v226, a202
    v_accvgpr_read_b32 v227, a203
    buffer_load_dwordx4 a[44:47], v4, s[28:31], s43 offen offset:3072
    v_accvgpr_read_b32 v228, a204
    v_accvgpr_read_b32 v229, a205
    v_accvgpr_read_b32 v230, a206
    v_accvgpr_read_b32 v231, a207
    v_accvgpr_read_b32 v232, a208
    v_accvgpr_read_b32 v233, a209
    s_movk_i32 s43, 12288
    buffer_load_dwordx4 a[48:51], v4, s[28:31], s43 offen offset:0
    v_accvgpr_read_b32 v234, a210
    v_accvgpr_read_b32 v235, a211
    v_accvgpr_read_b32 v236, a212
    v_accvgpr_read_b32 v237, a213
    v_accvgpr_read_b32 v238, a214
    v_accvgpr_read_b32 v239, a215
    buffer_load_dwordx4 a[52:55], v4, s[28:31], s43 offen offset:1024
    v_accvgpr_read_b32 v240, a216
    v_accvgpr_read_b32 v241, a217
    v_accvgpr_read_b32 v242, a218
    v_accvgpr_read_b32 v243, a219
    v_cvt_pk_bf16_f32 v208, v224, v225
    v_cvt_pk_bf16_f32 v209, v226, v227
    buffer_load_dwordx4 a[56:59], v4, s[28:31], s43 offen offset:2048
    v_cvt_pk_bf16_f32 v210, v232, 0
    v_mov_b32 v211, 0
    v_cvt_pk_bf16_f32 v212, v228, v229
    v_cvt_pk_bf16_f32 v213, v230, v231
    v_cvt_pk_bf16_f32 v214, v233, 0
    v_mov_b32 v215, 0
    buffer_load_dwordx4 a[60:63], v4, s[28:31], s43 offen offset:3072
    v_cvt_pk_bf16_f32 v217, v234, v235
    v_cvt_pk_bf16_f32 v218, v236, v237
    v_cvt_pk_bf16_f32 v219, v242, 0
    v_mov_b32 v216, 0
    v_cvt_pk_bf16_f32 v221, v238, v239
    v_cvt_pk_bf16_f32 v222, v240, v241
    s_movk_i32 s43, 16384
    buffer_load_dwordx4 a[64:67], v4, s[28:31], s43 offen offset:0
    v_cvt_pk_bf16_f32 v223, v243, 0
    v_mov_b32 v220, 0
    s_mov_b32 s45, 0x358637bd
    s_waitcnt vmcnt(17)
    v_mfma_f32_16x16x32_bf16 v[224:227], v[160:163], v[16:19], 0
    v_mfma_f32_16x16x32_bf16 v[228:231], v[164:167], v[16:19], 0
    v_mfma_f32_16x16x32_bf16 v[12:15], v[168:171], v[18:21], 0
    v_mfma_f32_16x16x32_bf16 v[8:11], v[172:175], v[18:21], 0
    buffer_load_dwordx4 a[68:71], v4, s[28:31], s43 offen offset:1024
    s_nop 5
    v_add_f32 v229, s45, v229
    v_rcp_f32 v229, v229
    s_nop 0
    v_mul_f32 v224, v224, v229
    v_mul_f32 v225, v225, v229
    buffer_load_dwordx4 a[72:75], v4, s[28:31], s43 offen offset:2048
    v_mul_f32 v226, v226, v229
    v_mul_f32 v227, v227, v229
    v_mul_f32 v228, v228, v229
    v_cvt_pk_bf16_f32 v232, v224, v225
    v_cvt_pk_bf16_f32 v233, v226, v227
    v_mov_b32 v252, v228
    buffer_load_dwordx4 a[76:79], v4, s[28:31], s43 offen offset:3072
    v_mfma_f32_16x16x32_bf16 v[224:227], v[176:179], v[22:25], 0
    v_mfma_f32_16x16x32_bf16 v[228:231], v[180:183], v[22:25], 0
    v_add_f32 v9, s45, v9
    v_rcp_f32 v9, v9
    s_nop 0
    v_mul_f32 v12, v12, v9
    s_movk_i32 s43, 20480
    buffer_load_dwordx4 a[80:83], v4, s[28:31], s43 offen offset:0
    v_mul_f32 v13, v13, v9
    v_mul_f32 v14, v14, v9
    v_mul_f32 v15, v15, v9
    v_mul_f32 v8, v8, v9
    v_cvt_pk_bf16_f32 v234, v252, v12
    v_cvt_pk_bf16_f32 v235, v13, v14
    buffer_load_dwordx4 a[84:87], v4, s[28:31], s43 offen offset:1024
    v_cvt_pk_bf16_f32 v236, v15, v8
    v_mfma_f32_16x16x32_bf16 v[12:15], v[184:187], v[24:27], 0
    v_mfma_f32_16x16x32_bf16 v[8:11], v[188:191], v[24:27], 0
    v_add_f32 v229, s45, v229
    v_rcp_f32 v229, v229
    s_nop 0
    buffer_load_dwordx4 a[88:91], v4, s[28:31], s43 offen offset:2048
    v_mul_f32 v224, v224, v229
    v_mul_f32 v225, v225, v229
    v_mul_f32 v226, v226, v229
    v_mul_f32 v227, v227, v229
    v_mul_f32 v228, v228, v229
    v_cvt_pk_bf16_f32 v237, v224, v225
    buffer_load_dwordx4 a[92:95], v4, s[28:31], s43 offen offset:3072
    v_cvt_pk_bf16_f32 v238, v226, v227
    v_mov_b32 v252, v228
    v_mfma_f32_16x16x32_bf16 v[224:227], v[192:195], v[28:31], 0
    v_mfma_f32_16x16x32_bf16 v[228:231], v[196:199], v[28:31], 0
    v_add_f32 v9, s45, v9
    v_rcp_f32 v9, v9
    s_movk_i32 s43, 24576
    buffer_load_dwordx4 a[96:99], v4, s[28:31], s43 offen offset:0
    s_nop 0
    v_mul_f32 v12, v12, v9
    v_mul_f32 v13, v13, v9
    v_mul_f32 v14, v14, v9
    v_mul_f32 v15, v15, v9
    v_mul_f32 v8, v8, v9
    s_mov_b32 s42, 24576
    buffer_load_dwordx4 v[40:43], v4, s[20:23], s42 offen offset:0
    v_cvt_pk_bf16_f32 v239, v252, v12
    v_cvt_pk_bf16_f32 v240, v13, v14
    v_cvt_pk_bf16_f32 v241, v15, v8
    v_mfma_f32_16x16x32_bf16 v[12:15], v[200:203], v[30:33], 0
    v_mfma_f32_16x16x32_bf16 v[8:11], v[204:207], v[30:33], 0
    v_add_f32 v229, s45, v229
    s_mov_b32 s42, 24576
    buffer_load_dwordx4 v[44:47], v4, s[20:23], s42 offen offset:1024
    v_rcp_f32 v229, v229
    s_nop 0
    v_mul_f32 v224, v224, v229
    v_mul_f32 v225, v225, v229
    v_mul_f32 v226, v226, v229
    v_mul_f32 v227, v227, v229
    s_mov_b32 s42, 24576
    buffer_load_dwordx4 v[48:51], v4, s[20:23], s42 offen offset:2048
    v_mul_f32 v228, v228, v229
    v_cvt_pk_bf16_f32 v242, v224, v225
    v_cvt_pk_bf16_f32 v243, v226, v227
    v_mov_b32 v252, v228
    v_mfma_f32_16x16x32_bf16 v[224:227], v[208:211], v[34:37], 0
    v_mfma_f32_16x16x32_bf16 v[228:231], v[212:215], v[34:37], 0
    s_mov_b32 s42, 24576
    buffer_load_dwordx4 v[52:55], v4, s[20:23], s42 offen offset:3072
    v_add_f32 v9, s45, v9
    v_rcp_f32 v9, v9
    s_nop 0
    v_mul_f32 v12, v12, v9
    v_mul_f32 v13, v13, v9
    v_mul_f32 v14, v14, v9
    s_mov_b32 s42, 28672
    buffer_load_dwordx4 v[56:59], v4, s[20:23], s42 offen offset:0
    v_mul_f32 v15, v15, v9
    v_mul_f32 v8, v8, v9
    v_cvt_pk_bf16_f32 v244, v252, v12
    v_cvt_pk_bf16_f32 v245, v13, v14
    v_cvt_pk_bf16_f32 v246, v15, v8
    v_mfma_f32_16x16x32_bf16 v[12:15], v[216:219], v[36:39], 0
    s_mov_b32 s42, 28672
    buffer_load_dwordx4 v[60:63], v4, s[20:23], s42 offen offset:1024
    v_mfma_f32_16x16x32_bf16 v[8:11], v[220:223], v[36:39], 0
    v_add_f32 v229, s45, v229
    v_rcp_f32 v229, v229
    s_nop 0
    v_mul_f32 v224, v224, v229
    v_mul_f32 v225, v225, v229
    s_mov_b32 s42, 49152
    buffer_load_dwordx4 v[64:67], v4, s[20:23], s42 offen offset:0
    v_mul_f32 v226, v226, v229
    v_mul_f32 v227, v227, v229
    v_mul_f32 v228, v228, v229
    v_cvt_pk_bf16_f32 v247, v224, v225
    v_cvt_pk_bf16_f32 v248, v226, v227
    v_mov_b32 v252, v228
    s_mov_b32 s42, 49152
    buffer_load_dwordx4 v[68:71], v4, s[20:23], s42 offen offset:1024
    s_nop 7
    v_add_f32 v9, s45, v9
    v_rcp_f32 v9, v9
    s_nop 0
    v_mul_f32 v12, v12, v9
    v_mul_f32 v13, v13, v9
    s_mov_b32 s42, 49152
    buffer_load_dwordx4 v[72:75], v4, s[20:23], s42 offen offset:2048
    v_mul_f32 v14, v14, v9
    v_mul_f32 v15, v15, v9
    v_mul_f32 v8, v8, v9
    v_cvt_pk_bf16_f32 v249, v252, v12
    v_cvt_pk_bf16_f32 v250, v13, v14
    v_cvt_pk_bf16_f32 v251, v15, v8
    s_mov_b32 s42, 49152
    buffer_load_dwordx4 v[76:79], v4, s[20:23], s42 offen offset:3072
    s_nop 1
    s_waitcnt vmcnt(30)
    v_mfma_f32_16x16x32_bf16 a[100:103], a[0:3], v[232:235], a[100:103]
    v_mfma_f32_16x16x32_bf16 a[104:107], a[4:7], v[232:235], a[104:107]
    v_mfma_f32_16x16x32_bf16 a[108:111], a[8:11], v[232:235], a[108:111]
    v_mfma_f32_16x16x32_bf16 a[112:115], a[12:15], v[232:235], a[112:115]
    v_mfma_f32_16x16x32_bf16 a[116:119], a[16:19], v[232:235], a[116:119]
    s_mov_b32 s42, 53248
    buffer_load_dwordx4 v[80:83], v4, s[20:23], s42 offen offset:0
    s_waitcnt vmcnt(26)
    v_mfma_f32_16x16x32_bf16 a[100:103], a[20:23], v[236:239], a[100:103]
    v_mfma_f32_16x16x32_bf16 a[104:107], a[24:27], v[236:239], a[104:107]
    v_mfma_f32_16x16x32_bf16 a[108:111], a[28:31], v[236:239], a[108:111]
    v_mfma_f32_16x16x32_bf16 a[112:115], a[32:35], v[236:239], a[112:115]
    v_mfma_f32_16x16x32_bf16 a[116:119], a[36:39], v[236:239], a[116:119]
    s_waitcnt vmcnt(21)
    v_mfma_f32_16x16x32_bf16 a[100:103], a[40:43], v[240:243], a[100:103]
    s_mov_b32 s42, 53248
    buffer_load_dwordx4 v[84:87], v4, s[20:23], s42 offen offset:1024
    v_mfma_f32_16x16x32_bf16 a[104:107], a[44:47], v[240:243], a[104:107]
    v_mfma_f32_16x16x32_bf16 a[108:111], a[48:51], v[240:243], a[108:111]
    v_mfma_f32_16x16x32_bf16 a[112:115], a[52:55], v[240:243], a[112:115]
    v_mfma_f32_16x16x32_bf16 a[116:119], a[56:59], v[240:243], a[116:119]
    s_waitcnt vmcnt(17)
    v_mfma_f32_16x16x32_bf16 a[100:103], a[60:63], v[244:247], a[100:103]
    v_mfma_f32_16x16x32_bf16 a[104:107], a[64:67], v[244:247], a[104:107]
    s_mov_b32 s42, 73728
    buffer_load_dwordx4 v[88:91], v4, s[20:23], s42 offen offset:0
    v_mfma_f32_16x16x32_bf16 a[108:111], a[68:71], v[244:247], a[108:111]
    v_mfma_f32_16x16x32_bf16 a[112:115], a[72:75], v[244:247], a[112:115]
    v_mfma_f32_16x16x32_bf16 a[116:119], a[76:79], v[244:247], a[116:119]
    s_waitcnt vmcnt(13)
    v_mfma_f32_16x16x32_bf16 a[100:103], a[80:83], v[248:251], a[100:103]
    v_mfma_f32_16x16x32_bf16 a[104:107], a[84:87], v[248:251], a[104:107]
    v_mfma_f32_16x16x32_bf16 a[108:111], a[88:91], v[248:251], a[108:111]
    s_mov_b32 s42, 73728
    buffer_load_dwordx4 v[92:95], v4, s[20:23], s42 offen offset:1024
    v_mfma_f32_16x16x32_bf16 a[112:115], a[92:95], v[248:251], a[112:115]
    v_mfma_f32_16x16x32_bf16 a[116:119], a[96:99], v[248:251], a[116:119]
    s_waitcnt vmcnt(8)
    v_mfma_f32_16x16x32_bf16 v[224:227], v[160:163], v[40:43], 0
    v_mfma_f32_16x16x32_bf16 v[228:231], v[164:167], v[40:43], 0
    v_mfma_f32_16x16x32_bf16 v[12:15], v[168:171], v[42:45], 0
    v_mfma_f32_16x16x32_bf16 v[8:11], v[172:175], v[42:45], 0
    s_mov_b32 s42, 73728
    buffer_load_dwordx4 v[96:99], v4, s[20:23], s42 offen offset:2048
    s_nop 5
    v_add_f32 v229, s45, v229
    v_rcp_f32 v229, v229
    s_nop 0
    v_mul_f32 v224, v224, v229
    v_mul_f32 v225, v225, v229
    s_mov_b32 s42, 73728
    buffer_load_dwordx4 v[100:103], v4, s[20:23], s42 offen offset:3072
    v_mul_f32 v226, v226, v229
    v_mul_f32 v227, v227, v229
    v_mul_f32 v228, v228, v229
    v_cvt_pk_bf16_f32 v232, v224, v225
    v_cvt_pk_bf16_f32 v233, v226, v227
    v_mov_b32 v252, v228
    s_mov_b32 s42, 77824
    buffer_load_dwordx4 v[104:107], v4, s[20:23], s42 offen offset:0
    v_mfma_f32_16x16x32_bf16 v[224:227], v[176:179], v[46:49], 0
    v_mfma_f32_16x16x32_bf16 v[228:231], v[180:183], v[46:49], 0
    v_add_f32 v9, s45, v9
    v_rcp_f32 v9, v9
    s_nop 0
    v_mul_f32 v12, v12, v9
    s_mov_b32 s42, 77824
    buffer_load_dwordx4 v[108:111], v4, s[20:23], s42 offen offset:1024
    v_mul_f32 v13, v13, v9
    v_mul_f32 v14, v14, v9
    v_mul_f32 v15, v15, v9
    v_mul_f32 v8, v8, v9
    v_cvt_pk_bf16_f32 v234, v252, v12
    v_cvt_pk_bf16_f32 v235, v13, v14
    buffer_load_dwordx2 a[240:241], v7, s[32:35], 0 offen offset:0
    v_cvt_pk_bf16_f32 v236, v15, v8
    v_mfma_f32_16x16x32_bf16 v[12:15], v[184:187], v[48:51], 0
    v_mfma_f32_16x16x32_bf16 v[8:11], v[188:191], v[48:51], 0
    v_add_f32 v229, s45, v229
    v_rcp_f32 v229, v229
    s_nop 0
    buffer_load_dwordx2 a[242:243], v7, s[32:35], 0 offen offset:32
    v_mul_f32 v224, v224, v229
    v_mul_f32 v225, v225, v229
    v_mul_f32 v226, v226, v229
    v_mul_f32 v227, v227, v229
    v_mul_f32 v228, v228, v229
    v_cvt_pk_bf16_f32 v237, v224, v225
    buffer_load_dwordx2 a[244:245], v7, s[32:35], 0 offen offset:64
    v_cvt_pk_bf16_f32 v238, v226, v227
    v_mov_b32 v252, v228
    v_mfma_f32_16x16x32_bf16 v[224:227], v[192:195], v[52:55], 0
    v_mfma_f32_16x16x32_bf16 v[228:231], v[196:199], v[52:55], 0
    v_add_f32 v9, s45, v9
    v_rcp_f32 v9, v9
    buffer_load_dwordx2 a[246:247], v7, s[32:35], 0 offen offset:96
    s_nop 0
    v_mul_f32 v12, v12, v9
    v_mul_f32 v13, v13, v9
    v_mul_f32 v14, v14, v9
    v_mul_f32 v15, v15, v9
    v_mul_f32 v8, v8, v9
    buffer_load_dwordx2 a[248:249], v7, s[32:35], 0 offen offset:128
    v_cvt_pk_bf16_f32 v239, v252, v12
    v_cvt_pk_bf16_f32 v240, v13, v14
    v_cvt_pk_bf16_f32 v241, v15, v8
    v_mfma_f32_16x16x32_bf16 v[12:15], v[200:203], v[54:57], 0
    v_mfma_f32_16x16x32_bf16 v[8:11], v[204:207], v[54:57], 0
    v_add_f32 v229, s45, v229
    v_rcp_f32 v229, v229
    s_nop 0
    v_mul_f32 v224, v224, v229
    v_mul_f32 v225, v225, v229
    v_mul_f32 v226, v226, v229
    v_mul_f32 v227, v227, v229
    v_mul_f32 v228, v228, v229
    v_cvt_pk_bf16_f32 v242, v224, v225
    v_cvt_pk_bf16_f32 v243, v226, v227
    v_mov_b32 v252, v228
    v_mfma_f32_16x16x32_bf16 v[224:227], v[208:211], v[58:61], 0
    v_mfma_f32_16x16x32_bf16 v[228:231], v[212:215], v[58:61], 0
    v_add_f32 v9, s45, v9
    v_rcp_f32 v9, v9
    s_nop 0
    v_mul_f32 v12, v12, v9
    v_mul_f32 v13, v13, v9
    v_mul_f32 v14, v14, v9
    v_mul_f32 v15, v15, v9
    v_mul_f32 v8, v8, v9
    v_cvt_pk_bf16_f32 v244, v252, v12
    v_cvt_pk_bf16_f32 v245, v13, v14
    v_cvt_pk_bf16_f32 v246, v15, v8
    v_mfma_f32_16x16x32_bf16 v[12:15], v[216:219], v[60:63], 0
    v_mfma_f32_16x16x32_bf16 v[8:11], v[220:223], v[60:63], 0
    v_add_f32 v229, s45, v229
    v_rcp_f32 v229, v229
    s_nop 0
    v_mul_f32 v224, v224, v229
    v_mul_f32 v225, v225, v229
    v_mul_f32 v226, v226, v229
    v_mul_f32 v227, v227, v229
    v_mul_f32 v228, v228, v229
    v_cvt_pk_bf16_f32 v247, v224, v225
    v_cvt_pk_bf16_f32 v248, v226, v227
    v_mov_b32 v252, v228
    s_nop 7
    v_add_f32 v9, s45, v9
    v_rcp_f32 v9, v9
    s_nop 0
    v_mul_f32 v12, v12, v9
    v_mul_f32 v13, v13, v9
    v_mul_f32 v14, v14, v9
    v_mul_f32 v15, v15, v9
    v_mul_f32 v8, v8, v9
    v_cvt_pk_bf16_f32 v249, v252, v12
    v_cvt_pk_bf16_f32 v250, v13, v14
    v_cvt_pk_bf16_f32 v251, v15, v8
    s_nop 1
    v_mfma_f32_16x16x32_bf16 a[120:123], a[0:3], v[232:235], a[120:123]
    v_mfma_f32_16x16x32_bf16 a[124:127], a[4:7], v[232:235], a[124:127]
    v_mfma_f32_16x16x32_bf16 a[128:131], a[8:11], v[232:235], a[128:131]
    v_mfma_f32_16x16x32_bf16 a[132:135], a[12:15], v[232:235], a[132:135]
    v_mfma_f32_16x16x32_bf16 a[136:139], a[16:19], v[232:235], a[136:139]
    v_mfma_f32_16x16x32_bf16 a[120:123], a[20:23], v[236:239], a[120:123]
    v_mfma_f32_16x16x32_bf16 a[124:127], a[24:27], v[236:239], a[124:127]
    v_mfma_f32_16x16x32_bf16 a[128:131], a[28:31], v[236:239], a[128:131]
    v_mfma_f32_16x16x32_bf16 a[132:135], a[32:35], v[236:239], a[132:135]
    v_mfma_f32_16x16x32_bf16 a[136:139], a[36:39], v[236:239], a[136:139]
    v_mfma_f32_16x16x32_bf16 a[120:123], a[40:43], v[240:243], a[120:123]
    v_mfma_f32_16x16x32_bf16 a[124:127], a[44:47], v[240:243], a[124:127]
    v_mfma_f32_16x16x32_bf16 a[128:131], a[48:51], v[240:243], a[128:131]
    v_mfma_f32_16x16x32_bf16 a[132:135], a[52:55], v[240:243], a[132:135]
    v_mfma_f32_16x16x32_bf16 a[136:139], a[56:59], v[240:243], a[136:139]
    v_mfma_f32_16x16x32_bf16 a[120:123], a[60:63], v[244:247], a[120:123]
    v_mfma_f32_16x16x32_bf16 a[124:127], a[64:67], v[244:247], a[124:127]
    v_mfma_f32_16x16x32_bf16 a[128:131], a[68:71], v[244:247], a[128:131]
    v_mfma_f32_16x16x32_bf16 a[132:135], a[72:75], v[244:247], a[132:135]
    v_mfma_f32_16x16x32_bf16 a[136:139], a[76:79], v[244:247], a[136:139]
    v_mfma_f32_16x16x32_bf16 a[120:123], a[80:83], v[248:251], a[120:123]
    v_mfma_f32_16x16x32_bf16 a[124:127], a[84:87], v[248:251], a[124:127]
    v_mfma_f32_16x16x32_bf16 a[128:131], a[88:91], v[248:251], a[128:131]
    v_mfma_f32_16x16x32_bf16 a[132:135], a[92:95], v[248:251], a[132:135]
    v_mfma_f32_16x16x32_bf16 a[136:139], a[96:99], v[248:251], a[136:139]
    s_waitcnt vmcnt(11)
    v_mfma_f32_16x16x32_bf16 v[224:227], v[160:163], v[64:67], 0
    v_mfma_f32_16x16x32_bf16 v[228:231], v[164:167], v[64:67], 0
    v_mfma_f32_16x16x32_bf16 v[12:15], v[168:171], v[66:69], 0
    v_mfma_f32_16x16x32_bf16 v[8:11], v[172:175], v[66:69], 0
    s_nop 5
    v_add_f32 v229, s45, v229
    v_rcp_f32 v229, v229
    s_nop 0
    v_mul_f32 v224, v224, v229
    v_mul_f32 v225, v225, v229
    v_mul_f32 v226, v226, v229
    v_mul_f32 v227, v227, v229
    v_mul_f32 v228, v228, v229
    v_cvt_pk_bf16_f32 v232, v224, v225
    v_cvt_pk_bf16_f32 v233, v226, v227
    v_mov_b32 v252, v228
    v_mfma_f32_16x16x32_bf16 v[224:227], v[176:179], v[70:73], 0
    v_mfma_f32_16x16x32_bf16 v[228:231], v[180:183], v[70:73], 0
    v_add_f32 v9, s45, v9
    v_rcp_f32 v9, v9
    s_nop 0
    v_mul_f32 v12, v12, v9
    v_mul_f32 v13, v13, v9
    v_mul_f32 v14, v14, v9
    v_mul_f32 v15, v15, v9
    v_mul_f32 v8, v8, v9
    v_cvt_pk_bf16_f32 v234, v252, v12
    v_cvt_pk_bf16_f32 v235, v13, v14
    v_cvt_pk_bf16_f32 v236, v15, v8
    v_mfma_f32_16x16x32_bf16 v[12:15], v[184:187], v[72:75], 0
    v_mfma_f32_16x16x32_bf16 v[8:11], v[188:191], v[72:75], 0
    v_add_f32 v229, s45, v229
    v_rcp_f32 v229, v229
    s_nop 0
    v_mul_f32 v224, v224, v229
    v_mul_f32 v225, v225, v229
    v_mul_f32 v226, v226, v229
    v_mul_f32 v227, v227, v229
    v_mul_f32 v228, v228, v229
    v_cvt_pk_bf16_f32 v237, v224, v225
    v_cvt_pk_bf16_f32 v238, v226, v227
    v_mov_b32 v252, v228
    v_mfma_f32_16x16x32_bf16 v[224:227], v[192:195], v[76:79], 0
    v_mfma_f32_16x16x32_bf16 v[228:231], v[196:199], v[76:79], 0
    v_add_f32 v9, s45, v9
    v_rcp_f32 v9, v9
    s_nop 0
    v_mul_f32 v12, v12, v9
    v_mul_f32 v13, v13, v9
    v_mul_f32 v14, v14, v9
    v_mul_f32 v15, v15, v9
    v_mul_f32 v8, v8, v9
    v_cvt_pk_bf16_f32 v239, v252, v12
    v_cvt_pk_bf16_f32 v240, v13, v14
    v_cvt_pk_bf16_f32 v241, v15, v8
    v_mfma_f32_16x16x32_bf16 v[12:15], v[200:203], v[78:81], 0
    v_mfma_f32_16x16x32_bf16 v[8:11], v[204:207], v[78:81], 0
    v_add_f32 v229, s45, v229
    v_rcp_f32 v229, v229
    s_nop 0
    v_mul_f32 v224, v224, v229
    v_mul_f32 v225, v225, v229
    v_mul_f32 v226, v226, v229
    v_mul_f32 v227, v227, v229
    v_mul_f32 v228, v228, v229
    v_cvt_pk_bf16_f32 v242, v224, v225
    v_cvt_pk_bf16_f32 v243, v226, v227
    v_mov_b32 v252, v228
    v_mfma_f32_16x16x32_bf16 v[224:227], v[208:211], v[82:85], 0
    v_mfma_f32_16x16x32_bf16 v[228:231], v[212:215], v[82:85], 0
    v_add_f32 v9, s45, v9
    v_rcp_f32 v9, v9
    s_nop 0
    v_mul_f32 v12, v12, v9
    v_mul_f32 v13, v13, v9
    v_mul_f32 v14, v14, v9
    v_mul_f32 v15, v15, v9
    v_mul_f32 v8, v8, v9
    v_cvt_pk_bf16_f32 v244, v252, v12
    v_cvt_pk_bf16_f32 v245, v13, v14
    v_cvt_pk_bf16_f32 v246, v15, v8
    v_mfma_f32_16x16x32_bf16 v[12:15], v[216:219], v[84:87], 0
    v_mfma_f32_16x16x32_bf16 v[8:11], v[220:223], v[84:87], 0
    v_add_f32 v229, s45, v229
    v_rcp_f32 v229, v229
    s_nop 0
    v_mul_f32 v224, v224, v229
    v_mul_f32 v225, v225, v229
    v_mul_f32 v226, v226, v229
    v_mul_f32 v227, v227, v229
    v_mul_f32 v228, v228, v229
    v_cvt_pk_bf16_f32 v247, v224, v225
    v_cvt_pk_bf16_f32 v248, v226, v227
    v_mov_b32 v252, v228
    s_nop 7
    v_add_f32 v9, s45, v9
    v_rcp_f32 v9, v9
    s_nop 0
    v_mul_f32 v12, v12, v9
    v_mul_f32 v13, v13, v9
    v_mul_f32 v14, v14, v9
    v_mul_f32 v15, v15, v9
    v_mul_f32 v8, v8, v9
    v_cvt_pk_bf16_f32 v249, v252, v12
    v_cvt_pk_bf16_f32 v250, v13, v14
    v_cvt_pk_bf16_f32 v251, v15, v8
    s_nop 1
    v_mfma_f32_16x16x32_bf16 a[140:143], a[0:3], v[232:235], a[140:143]
    v_mfma_f32_16x16x32_bf16 a[144:147], a[4:7], v[232:235], a[144:147]
    v_mfma_f32_16x16x32_bf16 a[148:151], a[8:11], v[232:235], a[148:151]
    v_mfma_f32_16x16x32_bf16 a[152:155], a[12:15], v[232:235], a[152:155]
    v_mfma_f32_16x16x32_bf16 a[156:159], a[16:19], v[232:235], a[156:159]
    v_mfma_f32_16x16x32_bf16 a[140:143], a[20:23], v[236:239], a[140:143]
    v_mfma_f32_16x16x32_bf16 a[144:147], a[24:27], v[236:239], a[144:147]
    v_mfma_f32_16x16x32_bf16 a[148:151], a[28:31], v[236:239], a[148:151]
    v_mfma_f32_16x16x32_bf16 a[152:155], a[32:35], v[236:239], a[152:155]
    v_mfma_f32_16x16x32_bf16 a[156:159], a[36:39], v[236:239], a[156:159]
    v_mfma_f32_16x16x32_bf16 a[140:143], a[40:43], v[240:243], a[140:143]
    v_mfma_f32_16x16x32_bf16 a[144:147], a[44:47], v[240:243], a[144:147]
    v_mfma_f32_16x16x32_bf16 a[148:151], a[48:51], v[240:243], a[148:151]
    v_mfma_f32_16x16x32_bf16 a[152:155], a[52:55], v[240:243], a[152:155]
    v_mfma_f32_16x16x32_bf16 a[156:159], a[56:59], v[240:243], a[156:159]
    v_mfma_f32_16x16x32_bf16 a[140:143], a[60:63], v[244:247], a[140:143]
    v_mfma_f32_16x16x32_bf16 a[144:147], a[64:67], v[244:247], a[144:147]
    v_mfma_f32_16x16x32_bf16 a[148:151], a[68:71], v[244:247], a[148:151]
    v_mfma_f32_16x16x32_bf16 a[152:155], a[72:75], v[244:247], a[152:155]
    v_mfma_f32_16x16x32_bf16 a[156:159], a[76:79], v[244:247], a[156:159]
    v_mfma_f32_16x16x32_bf16 a[140:143], a[80:83], v[248:251], a[140:143]
    v_mfma_f32_16x16x32_bf16 a[144:147], a[84:87], v[248:251], a[144:147]
    v_mfma_f32_16x16x32_bf16 a[148:151], a[88:91], v[248:251], a[148:151]
    v_mfma_f32_16x16x32_bf16 a[152:155], a[92:95], v[248:251], a[152:155]
    v_mfma_f32_16x16x32_bf16 a[156:159], a[96:99], v[248:251], a[156:159]
    s_waitcnt vmcnt(5)
    v_mfma_f32_16x16x32_bf16 v[224:227], v[160:163], v[88:91], 0
    v_mfma_f32_16x16x32_bf16 v[228:231], v[164:167], v[88:91], 0
    v_mfma_f32_16x16x32_bf16 v[12:15], v[168:171], v[90:93], 0
    v_mfma_f32_16x16x32_bf16 v[8:11], v[172:175], v[90:93], 0
    s_nop 5
    v_add_f32 v229, s45, v229
    v_rcp_f32 v229, v229
    s_nop 0
    v_mul_f32 v224, v224, v229
    v_mul_f32 v225, v225, v229
    v_mul_f32 v226, v226, v229
    v_mul_f32 v227, v227, v229
    v_mul_f32 v228, v228, v229
    v_cvt_pk_bf16_f32 v232, v224, v225
    v_cvt_pk_bf16_f32 v233, v226, v227
    v_mov_b32 v252, v228
    v_mfma_f32_16x16x32_bf16 v[224:227], v[176:179], v[94:97], 0
    v_mfma_f32_16x16x32_bf16 v[228:231], v[180:183], v[94:97], 0
    v_add_f32 v9, s45, v9
    v_rcp_f32 v9, v9
    s_nop 0
    v_mul_f32 v12, v12, v9
    v_mul_f32 v13, v13, v9
    v_mul_f32 v14, v14, v9
    v_mul_f32 v15, v15, v9
    v_mul_f32 v8, v8, v9
    v_cvt_pk_bf16_f32 v234, v252, v12
    v_cvt_pk_bf16_f32 v235, v13, v14
    v_cvt_pk_bf16_f32 v236, v15, v8
    v_mfma_f32_16x16x32_bf16 v[12:15], v[184:187], v[96:99], 0
    v_mfma_f32_16x16x32_bf16 v[8:11], v[188:191], v[96:99], 0
    v_add_f32 v229, s45, v229
    v_rcp_f32 v229, v229
    s_nop 0
    v_mul_f32 v224, v224, v229
    v_mul_f32 v225, v225, v229
    v_mul_f32 v226, v226, v229
    v_mul_f32 v227, v227, v229
    v_mul_f32 v228, v228, v229
    v_cvt_pk_bf16_f32 v237, v224, v225
    v_cvt_pk_bf16_f32 v238, v226, v227
    v_mov_b32 v252, v228
    v_mfma_f32_16x16x32_bf16 v[224:227], v[192:195], v[100:103], 0
    v_mfma_f32_16x16x32_bf16 v[228:231], v[196:199], v[100:103], 0
    v_add_f32 v9, s45, v9
    v_rcp_f32 v9, v9
    s_nop 0
    v_mul_f32 v12, v12, v9
    v_mul_f32 v13, v13, v9
    v_mul_f32 v14, v14, v9
    v_mul_f32 v15, v15, v9
    v_mul_f32 v8, v8, v9
    v_cvt_pk_bf16_f32 v239, v252, v12
    v_cvt_pk_bf16_f32 v240, v13, v14
    v_cvt_pk_bf16_f32 v241, v15, v8
    v_mfma_f32_16x16x32_bf16 v[12:15], v[200:203], v[102:105], 0
    v_mfma_f32_16x16x32_bf16 v[8:11], v[204:207], v[102:105], 0
    v_add_f32 v229, s45, v229
    v_rcp_f32 v229, v229
    s_nop 0
    v_mul_f32 v224, v224, v229
    v_mul_f32 v225, v225, v229
    v_mul_f32 v226, v226, v229
    v_mul_f32 v227, v227, v229
    v_mul_f32 v228, v228, v229
    v_cvt_pk_bf16_f32 v242, v224, v225
    v_cvt_pk_bf16_f32 v243, v226, v227
    v_mov_b32 v252, v228
    v_mfma_f32_16x16x32_bf16 v[224:227], v[208:211], v[106:109], 0
    v_mfma_f32_16x16x32_bf16 v[228:231], v[212:215], v[106:109], 0
    v_add_f32 v9, s45, v9
    v_rcp_f32 v9, v9
    s_nop 0
    v_mul_f32 v12, v12, v9
    v_mul_f32 v13, v13, v9
    v_mul_f32 v14, v14, v9
    v_mul_f32 v15, v15, v9
    v_mul_f32 v8, v8, v9
    v_cvt_pk_bf16_f32 v244, v252, v12
    v_cvt_pk_bf16_f32 v245, v13, v14
    v_cvt_pk_bf16_f32 v246, v15, v8
    v_mfma_f32_16x16x32_bf16 v[12:15], v[216:219], v[108:111], 0
    v_mfma_f32_16x16x32_bf16 v[8:11], v[220:223], v[108:111], 0
    v_add_f32 v229, s45, v229
    v_rcp_f32 v229, v229
    s_nop 0
    v_mul_f32 v224, v224, v229
    v_mul_f32 v225, v225, v229
    v_mul_f32 v226, v226, v229
    v_mul_f32 v227, v227, v229
    v_mul_f32 v228, v228, v229
    v_cvt_pk_bf16_f32 v247, v224, v225
    v_cvt_pk_bf16_f32 v248, v226, v227
    v_mov_b32 v252, v228
    s_nop 7
    v_add_f32 v9, s45, v9
    v_rcp_f32 v9, v9
    s_nop 0
    v_mul_f32 v12, v12, v9
    v_mul_f32 v13, v13, v9
    v_mul_f32 v14, v14, v9
    v_mul_f32 v15, v15, v9
    v_mul_f32 v8, v8, v9
    v_cvt_pk_bf16_f32 v249, v252, v12
    v_cvt_pk_bf16_f32 v250, v13, v14
    v_cvt_pk_bf16_f32 v251, v15, v8
    s_nop 1
    v_mfma_f32_16x16x32_bf16 a[160:163], a[0:3], v[232:235], a[160:163]
    v_mfma_f32_16x16x32_bf16 a[164:167], a[4:7], v[232:235], a[164:167]
    v_mfma_f32_16x16x32_bf16 a[168:171], a[8:11], v[232:235], a[168:171]
    v_mfma_f32_16x16x32_bf16 a[172:175], a[12:15], v[232:235], a[172:175]
    v_mfma_f32_16x16x32_bf16 a[176:179], a[16:19], v[232:235], a[176:179]
    v_mfma_f32_16x16x32_bf16 a[160:163], a[20:23], v[236:239], a[160:163]
    v_mfma_f32_16x16x32_bf16 a[164:167], a[24:27], v[236:239], a[164:167]
    v_mfma_f32_16x16x32_bf16 a[168:171], a[28:31], v[236:239], a[168:171]
    v_mfma_f32_16x16x32_bf16 a[172:175], a[32:35], v[236:239], a[172:175]
    v_mfma_f32_16x16x32_bf16 a[176:179], a[36:39], v[236:239], a[176:179]
    v_mfma_f32_16x16x32_bf16 a[160:163], a[40:43], v[240:243], a[160:163]
    v_mfma_f32_16x16x32_bf16 a[164:167], a[44:47], v[240:243], a[164:167]
    v_mfma_f32_16x16x32_bf16 a[168:171], a[48:51], v[240:243], a[168:171]
    v_mfma_f32_16x16x32_bf16 a[172:175], a[52:55], v[240:243], a[172:175]
    v_mfma_f32_16x16x32_bf16 a[176:179], a[56:59], v[240:243], a[176:179]
    v_mfma_f32_16x16x32_bf16 a[160:163], a[60:63], v[244:247], a[160:163]
    v_mfma_f32_16x16x32_bf16 a[164:167], a[64:67], v[244:247], a[164:167]
    v_mfma_f32_16x16x32_bf16 a[168:171], a[68:71], v[244:247], a[168:171]
    v_mfma_f32_16x16x32_bf16 a[172:175], a[72:75], v[244:247], a[172:175]
    v_mfma_f32_16x16x32_bf16 a[176:179], a[76:79], v[244:247], a[176:179]
    v_mfma_f32_16x16x32_bf16 a[160:163], a[80:83], v[248:251], a[160:163]
    v_mfma_f32_16x16x32_bf16 a[164:167], a[84:87], v[248:251], a[164:167]
    v_mfma_f32_16x16x32_bf16 a[168:171], a[88:91], v[248:251], a[168:171]
    v_mfma_f32_16x16x32_bf16 a[172:175], a[92:95], v[248:251], a[172:175]
    v_mfma_f32_16x16x32_bf16 a[176:179], a[96:99], v[248:251], a[176:179]
    s_waitcnt vmcnt(0)
    v_accvgpr_read_b32 v200, a240
    v_accvgpr_read_b32 v201, a241
    v_accvgpr_read_b32 v202, a242
    v_accvgpr_read_b32 v203, a243
    v_accvgpr_read_b32 v204, a244
    v_accvgpr_read_b32 v205, a245
    v_accvgpr_read_b32 v206, a246
    v_accvgpr_read_b32 v207, a247
    v_accvgpr_read_b32 v208, a248
    v_accvgpr_read_b32 v209, a249
    s_lshl_b32 s15, s12, 2
    s_add_u32 s15, s15, s14
    s_mul_i32 s15, s15, 20480
    s_add_u32 s15, s15, 4194304
    s_add_u32 s36, s10, s15
    s_addc_u32 s37, s11, 0
    s_and_b32 s37, s37, 0xffff
    s_mov_b32 s38, 0x5000
    s_mov_b32 s39, 0x00020000
    s_mul_i32 s44, s13, 5
    s_add_u32 s15, s44, 0
    s_lshr_b32 s45, s15, 1
    s_lshl_b32 s45, s45, 10
    s_and_b32 s15, s15, 1
    s_lshl_b32 s15, s15, 3
    s_add_u32 s48, s15, s45
    s_add_u32 s15, s44, 1
    s_lshr_b32 s45, s15, 1
    s_lshl_b32 s45, s45, 10
    s_and_b32 s15, s15, 1
    s_lshl_b32 s15, s15, 3
    s_add_u32 s49, s15, s45
    s_add_u32 s15, s44, 2
    s_lshr_b32 s45, s15, 1
    s_lshl_b32 s45, s45, 10
    s_and_b32 s15, s15, 1
    s_lshl_b32 s15, s15, 3
    s_add_u32 s50, s15, s45
    s_add_u32 s15, s44, 3
    s_lshr_b32 s45, s15, 1
    s_lshl_b32 s45, s45, 10
    s_and_b32 s15, s15, 1
    s_lshl_b32 s15, s15, 3
    s_add_u32 s51, s15, s45
    s_add_u32 s15, s44, 4
    s_lshr_b32 s45, s15, 1
    s_lshl_b32 s45, s45, 10
    s_and_b32 s15, s15, 1
    s_lshl_b32 s15, s15, 3
    s_add_u32 s52, s15, s45
    v_lshlrev_b32 v5, 4, v1
    s_mul_i32 s15, s14, 20480
    v_lshlrev_b32 v4, 4, v1
    v_add_u32 v6, s15, v4
    s_nop 7
    ds_write_b128 v6, a[100:103] offset:0
    ds_write_b128 v6, a[104:107] offset:1024
    ds_write_b128 v6, a[108:111] offset:2048
    ds_write_b128 v6, a[112:115] offset:3072
    ds_write_b128 v6, a[116:119] offset:4096
    ds_write_b128 v6, a[120:123] offset:5120
    ds_write_b128 v6, a[124:127] offset:6144
    ds_write_b128 v6, a[128:131] offset:7168
    ds_write_b128 v6, a[132:135] offset:8192
    ds_write_b128 v6, a[136:139] offset:9216
    ds_write_b128 v6, a[140:143] offset:10240
    ds_write_b128 v6, a[144:147] offset:11264
    ds_write_b128 v6, a[148:151] offset:12288
    ds_write_b128 v6, a[152:155] offset:13312
    ds_write_b128 v6, a[156:159] offset:14336
    ds_write_b128 v6, a[160:163] offset:15360
    ds_write_b128 v6, a[164:167] offset:16384
    ds_write_b128 v6, a[168:171] offset:17408
    ds_write_b128 v6, a[172:175] offset:18432
    ds_write_b128 v6, a[176:179] offset:19456
    s_waitcnt lgkmcnt(0)
    s_barrier
    s_mul_i32 s15, s14, 5120
    v_add_u32 v6, s15, v4
    v_add_u32 v7, 40960, v6
    ds_read_b128 v[16:19], v6 offset:0
    ds_read_b128 v[20:23], v6 offset:1024
    ds_read_b128 v[24:27], v6 offset:2048
    ds_read_b128 v[28:31], v6 offset:3072
    ds_read_b128 v[32:35], v6 offset:4096
    ds_read_b128 v[36:39], v6 offset:20480
    ds_read_b128 v[40:43], v6 offset:21504
    ds_read_b128 v[44:47], v6 offset:22528
    ds_read_b128 v[48:51], v6 offset:23552
    ds_read_b128 v[52:55], v6 offset:24576
    ds_read_b128 v[56:59], v7 offset:0
    ds_read_b128 v[60:63], v7 offset:1024
    ds_read_b128 v[64:67], v7 offset:2048
    ds_read_b128 v[68:71], v7 offset:3072
    ds_read_b128 v[72:75], v7 offset:4096
    ds_read_b128 v[76:79], v7 offset:20480
    ds_read_b128 v[80:83], v7 offset:21504
    ds_read_b128 v[84:87], v7 offset:22528
    ds_read_b128 v[88:91], v7 offset:23552
    ds_read_b128 v[92:95], v7 offset:24576
    s_waitcnt lgkmcnt(0)
    v_add_f32 v16, v16, v36
    v_add_f32 v56, v56, v76
    v_add_f32 v16, v16, v56
    v_add_f32 v17, v17, v37
    v_add_f32 v57, v57, v77
    v_add_f32 v17, v17, v57
    v_add_f32 v18, v18, v38
    v_add_f32 v58, v58, v78
    v_add_f32 v18, v18, v58
    v_add_f32 v19, v19, v39
    v_add_f32 v59, v59, v79
    v_add_f32 v19, v19, v59
    v_add_f32 v20, v20, v40
    v_add_f32 v60, v60, v80
    v_add_f32 v20, v20, v60
    v_add_f32 v21, v21, v41
    v_add_f32 v61, v61, v81
    v_add_f32 v21, v21, v61
    v_add_f32 v22, v22, v42
    v_add_f32 v62, v62, v82
    v_add_f32 v22, v22, v62
    v_add_f32 v23, v23, v43
    v_add_f32 v63, v63, v83
    v_add_f32 v23, v23, v63
    v_add_f32 v24, v24, v44
    v_add_f32 v64, v64, v84
    v_add_f32 v24, v24, v64
    v_add_f32 v25, v25, v45
    v_add_f32 v65, v65, v85
    v_add_f32 v25, v25, v65
    v_add_f32 v26, v26, v46
    v_add_f32 v66, v66, v86
    v_add_f32 v26, v26, v66
    v_add_f32 v27, v27, v47
    v_add_f32 v67, v67, v87
    v_add_f32 v27, v27, v67
    v_add_f32 v28, v28, v48
    v_add_f32 v68, v68, v88
    v_add_f32 v28, v28, v68
    v_add_f32 v29, v29, v49
    v_add_f32 v69, v69, v89
    v_add_f32 v29, v29, v69
    v_add_f32 v30, v30, v50
    v_add_f32 v70, v70, v90
    v_add_f32 v30, v30, v70
    v_add_f32 v31, v31, v51
    v_add_f32 v71, v71, v91
    v_add_f32 v31, v31, v71
    v_add_f32 v32, v32, v52
    v_add_f32 v72, v72, v92
    v_add_f32 v32, v32, v72
    v_add_f32 v33, v33, v53
    v_add_f32 v73, v73, v93
    v_add_f32 v33, v33, v73
    v_add_f32 v34, v34, v54
    v_add_f32 v74, v74, v94
    v_add_f32 v34, v34, v74
    v_add_f32 v35, v35, v55
    v_add_f32 v75, v75, v95
    v_add_f32 v35, v35, v75
    v_lshlrev_b32 v100, 16, v200
    v_and_b32 v101, 0xffff0000, v200
    v_add_f32 v16, v16, v100
    v_add_f32 v17, v17, v101
    v_lshlrev_b32 v100, 16, v201
    v_and_b32 v101, 0xffff0000, v201
    v_add_f32 v18, v18, v100
    v_add_f32 v19, v19, v101
    v_lshlrev_b32 v100, 16, v202
    v_and_b32 v101, 0xffff0000, v202
    v_add_f32 v20, v20, v100
    v_add_f32 v21, v21, v101
    v_lshlrev_b32 v100, 16, v203
    v_and_b32 v101, 0xffff0000, v203
    v_add_f32 v22, v22, v100
    v_add_f32 v23, v23, v101
    v_lshlrev_b32 v100, 16, v204
    v_and_b32 v101, 0xffff0000, v204
    v_add_f32 v24, v24, v100
    v_add_f32 v25, v25, v101
    v_lshlrev_b32 v100, 16, v205
    v_and_b32 v101, 0xffff0000, v205
    v_add_f32 v26, v26, v100
    v_add_f32 v27, v27, v101
    v_lshlrev_b32 v100, 16, v206
    v_and_b32 v101, 0xffff0000, v206
    v_add_f32 v28, v28, v100
    v_add_f32 v29, v29, v101
    v_lshlrev_b32 v100, 16, v207
    v_and_b32 v101, 0xffff0000, v207
    v_add_f32 v30, v30, v100
    v_add_f32 v31, v31, v101
    v_lshlrev_b32 v100, 16, v208
    v_and_b32 v101, 0xffff0000, v208
    v_add_f32 v32, v32, v100
    v_add_f32 v33, v33, v101
    v_lshlrev_b32 v100, 16, v209
    v_and_b32 v101, 0xffff0000, v209
    v_add_f32 v34, v34, v100
    v_add_f32 v35, v35, v101
    v_cvt_pk_bf16_f32 v110, v16, v17
    v_cvt_pk_bf16_f32 v111, v18, v19
    v_cvt_pk_bf16_f32 v112, v20, v21
    v_cvt_pk_bf16_f32 v113, v22, v23
    v_cvt_pk_bf16_f32 v114, v24, v25
    v_cvt_pk_bf16_f32 v115, v26, v27
    v_cvt_pk_bf16_f32 v116, v28, v29
    v_cvt_pk_bf16_f32 v117, v30, v31
    v_cvt_pk_bf16_f32 v118, v32, v33
    v_cvt_pk_bf16_f32 v119, v34, v35
    s_and_b32 s15, s13, 1
    s_cmp_eq_u32 s15, 1
    s_cbranch_scc1 k2odd_37
    buffer_store_dwordx4 v[110:113], v5, s[36:39], s48 offen
    buffer_store_dwordx4 v[114:117], v5, s[36:39], s50 offen
    buffer_store_dwordx2 v[118:119], v5, s[36:39], s52 offen
    s_branch k2sd_38
k2odd_37:
    buffer_store_dwordx2 v[110:111], v5, s[36:39], s48 offen
    buffer_store_dwordx4 v[112:115], v5, s[36:39], s49 offen
    buffer_store_dwordx4 v[116:119], v5, s[36:39], s51 offen
k2sd_38:
    v_mov_b32 v102, 0
    v_mov_b32 v103, 0
    v_lshlrev_b32 v100, 16, v110
    v_and_b32 v101, 0xffff0000, v110
    v_add_f32 v102, v102, v100
    v_fma_f32 v103, v100, v100, v103
    v_add_f32 v102, v102, v101
    v_fma_f32 v103, v101, v101, v103
    v_lshlrev_b32 v100, 16, v111
    v_and_b32 v101, 0xffff0000, v111
    v_add_f32 v102, v102, v100
    v_fma_f32 v103, v100, v100, v103
    v_add_f32 v102, v102, v101
    v_fma_f32 v103, v101, v101, v103
    v_lshlrev_b32 v100, 16, v112
    v_and_b32 v101, 0xffff0000, v112
    v_add_f32 v102, v102, v100
    v_fma_f32 v103, v100, v100, v103
    v_add_f32 v102, v102, v101
    v_fma_f32 v103, v101, v101, v103
    v_lshlrev_b32 v100, 16, v113
    v_and_b32 v101, 0xffff0000, v113
    v_add_f32 v102, v102, v100
    v_fma_f32 v103, v100, v100, v103
    v_add_f32 v102, v102, v101
    v_fma_f32 v103, v101, v101, v103
    v_lshlrev_b32 v100, 16, v114
    v_and_b32 v101, 0xffff0000, v114
    v_add_f32 v102, v102, v100
    v_fma_f32 v103, v100, v100, v103
    v_add_f32 v102, v102, v101
    v_fma_f32 v103, v101, v101, v103
    v_lshlrev_b32 v100, 16, v115
    v_and_b32 v101, 0xffff0000, v115
    v_add_f32 v102, v102, v100
    v_fma_f32 v103, v100, v100, v103
    v_add_f32 v102, v102, v101
    v_fma_f32 v103, v101, v101, v103
    v_lshlrev_b32 v100, 16, v116
    v_and_b32 v101, 0xffff0000, v116
    v_add_f32 v102, v102, v100
    v_fma_f32 v103, v100, v100, v103
    v_add_f32 v102, v102, v101
    v_fma_f32 v103, v101, v101, v103
    v_lshlrev_b32 v100, 16, v117
    v_and_b32 v101, 0xffff0000, v117
    v_add_f32 v102, v102, v100
    v_fma_f32 v103, v100, v100, v103
    v_add_f32 v102, v102, v101
    v_fma_f32 v103, v101, v101, v103
    v_lshlrev_b32 v100, 16, v118
    v_and_b32 v101, 0xffff0000, v118
    v_add_f32 v102, v102, v100
    v_fma_f32 v103, v100, v100, v103
    v_add_f32 v102, v102, v101
    v_fma_f32 v103, v101, v101, v103
    v_lshlrev_b32 v100, 16, v119
    v_and_b32 v101, 0xffff0000, v119
    v_add_f32 v102, v102, v100
    v_fma_f32 v103, v100, v100, v103
    v_add_f32 v102, v102, v101
    v_fma_f32 v103, v101, v101, v103
    v_xor_b32 v104, 16, v1
    v_lshlrev_b32 v104, 2, v104
    ds_bpermute_b32 v105, v104, v102
    ds_bpermute_b32 v106, v104, v103
    s_waitcnt lgkmcnt(0)
    v_add_f32 v102, v102, v105
    v_add_f32 v103, v103, v106
    v_xor_b32 v104, 32, v1
    v_lshlrev_b32 v104, 2, v104
    ds_bpermute_b32 v105, v104, v102
    ds_bpermute_b32 v106, v104, v103
    s_waitcnt lgkmcnt(0)
    v_add_f32 v102, v102, v105
    v_add_f32 v103, v103, v106
    s_lshl_b32 s15, s12, 2
    s_add_u32 s15, s15, s14
    s_lshl_b32 s15, s15, 10
    s_lshl_b32 s44, s13, 3
    s_add_u32 s15, s15, s44
    s_add_u32 s15, s15, 7340032
    s_add_u32 s36, s10, s15
    s_addc_u32 s37, s11, 0
    s_and_b32 s37, s37, 0xffff
    s_mov_b32 s38, 0x400
    s_mov_b32 s39, 0x00020000
    v_lshlrev_b32 v104, 6, v2
    s_mov_b64 exec, 0xffff
    buffer_store_dwordx2 v[102:103], v104, s[36:39], 0 offen
    s_mov_b64 exec, -1
k2_kernel_end:
    s_endpgm
.globl k3_kernel
.p2align 8
.type k3_kernel,@function
k3_kernel:
    s_cmp_ge_u32 s2, 256
    s_cbranch_scc1 k3_kernel_end
    s_cmp_ge_u32 s2, 16
    s_cbranch_scc1 pcq_41
    s_getpc_b64 s[94:95]
pc_39:
    s_add_u32 s94, s94, (k3_kernel-pc_39)&0xffffffff
    s_addc_u32 s95, s95, ((k3_kernel-pc_39)>>32)&0xffffffff
    v_lshlrev_b32 v250, 7, v0
    s_mov_b32 s96, k4_kernel_end-k3_kernel
    v_cmp_gt_u32 vcc, s96, v250
    s_and_saveexec_b64 s[98:99], vcc
    s_cbranch_execz pcs_40
    global_load_dword v251, v250, s[94:95] offset:0
pcs_40:
    s_mov_b64 exec, s[98:99]
pcq_41:
    s_load_dwordx2 s[10:11], s[0:1], 64
    v_and_b32 v1, 63, v0
    v_lshrrev_b32 v4, 6, v0
    s_and_b32 s15, s2, 7
    s_lshr_b32 s13, s2, 3
    v_readfirstlane_b32 s14, v4
    s_lshr_b32 s12, s13, 3
    s_lshr_b32 s16, s15, 1
    s_lshl_b32 s16, s16, 2
    s_add_u32 s12, s12, s16
    s_and_b32 s13, s13, 7
    s_and_b32 s15, s15, 1
    s_lshl_b32 s15, s15, 3
    s_add_u32 s13, s13, s15
    s_mul_i32 s13, s13, 27
    s_lshr_b32 s13, s13, 2
    v_and_b32 v2, 15, v1
    v_lshrrev_b32 v3, 4, v1
    v_lshlrev_b32 v4, 4, v1
    v_lshlrev_b32 v5, 3, v1
    s_lshl_b32 s15, s12, 3
    s_add_u32 s46, s15, s14
    s_mul_i32 s47, s14, 110592
    s_waitcnt lgkmcnt(0)
    s_mul_i32 s15, s46, 20480
    s_add_u32 s15, s15, 4194304
    s_add_u32 s16, s10, s15
    s_addc_u32 s17, s11, 0
    s_and_b32 s17, s17, 0xffff
    s_mov_b32 s18, 0x5000
    s_mov_b32 s19, 0x00020000
    s_lshl_b32 s15, s13, 10
    s_add_u32 s15, s15, 17825792
    s_add_u32 s20, s10, s15
    s_addc_u32 s21, s11, 0
    s_and_b32 s21, s21, 0xffff
    s_mov_b32 s22, 0x21c000
    s_mov_b32 s23, 0x00020000
    s_lshr_b32 s50, s14, 1
    s_and_b32 s51, s14, 1
    s_mul_i32 s47, s50, 110592
    s_lshl_b32 s52, s51, 12
    s_add_u32 s47, s47, s52
    s_mul_i32 s48, s50, 7168
    s_add_u32 s48, s48, s52
    s_mov_b32 s24, s20
    s_mov_b32 s25, s21
    s_mov_b32 s26, s22
    s_mov_b32 s27, s23
    s_cmp_eq_u32 s51, 0
    s_cselect_b32 s54, 1024, 0
    s_add_u32 m0, s48, 0
    s_add_u32 s49, s47, 0
    buffer_load_dwordx4 v4, s[20:23], s49 offen offset:0 lds
    buffer_load_dwordx4 v4, s[20:23], s49 offen offset:1024 lds
    buffer_load_dwordx4 v4, s[20:23], s49 offen offset:2048 lds
    s_add_u32 m0, m0, s54
    s_add_u32 s49, s49, s54
    buffer_load_dwordx4 v4, s[20:23], s49 offen offset:2048 lds
    s_movk_i32 s15, 0
    buffer_load_dwordx4 v[16:19], v4, s[16:19], s15 offen offset:0
    s_movk_i32 s15, 0
    buffer_load_dwordx4 v[20:23], v4, s[16:19], s15 offen offset:1024
    s_movk_i32 s15, 0
    buffer_load_dwordx4 v[24:27], v4, s[16:19], s15 offen offset:2048
    s_movk_i32 s15, 0
    buffer_load_dwordx4 v[28:31], v4, s[16:19], s15 offen offset:3072
    s_add_u32 m0, s48, 28672
    s_add_u32 s49, s47, 442368
    buffer_load_dwordx4 v4, s[20:23], s49 offen offset:0 lds
    buffer_load_dwordx4 v4, s[20:23], s49 offen offset:1024 lds
    buffer_load_dwordx4 v4, s[20:23], s49 offen offset:2048 lds
    s_add_u32 m0, m0, s54
    s_add_u32 s49, s49, s54
    buffer_load_dwordx4 v4, s[20:23], s49 offen offset:2048 lds
    s_movk_i32 s15, 4096
    buffer_load_dwordx4 v[32:35], v4, s[16:19], s15 offen offset:0
    s_movk_i32 s15, 4096
    buffer_load_dwordx4 v[36:39], v4, s[16:19], s15 offen offset:1024
    s_movk_i32 s15, 4096
    buffer_load_dwordx4 v[40:43], v4, s[16:19], s15 offen offset:2048
    s_movk_i32 s15, 4096
    buffer_load_dwordx4 v[44:47], v4, s[16:19], s15 offen offset:3072
    s_mul_i32 s15, s46, 1024
    s_add_u32 s15, s15, 7340032
    s_add_u32 s24, s10, s15
    s_addc_u32 s25, s11, 0
    s_and_b32 s25, s25, 0xffff
    s_mov_b32 s26, 0x400
    s_mov_b32 s27, 0x00020000
    buffer_load_dwordx4 v[212:215], v4, s[24:27], 0 offen
    v_mov_b32 v208, 0x3f803f80
    v_mov_b32 v209, 0x3f803f80
    v_mov_b32 v210, 0x3f803f80
    v_mov_b32 v211, 0x3f803f80
    v_mov_b32 v152, 0
    v_mov_b32 v153, 0
    v_mov_b32 v154, 0
    v_mov_b32 v155, 0
    v_mov_b32 v156, 0
    v_mov_b32 v157, 0
    v_mov_b32 v158, 0
    v_mov_b32 v159, 0
    v_mov_b32 v160, 0
    v_mov_b32 v161, 0
    v_mov_b32 v162, 0
    v_mov_b32 v163, 0
    v_mov_b32 v164, 0
    v_mov_b32 v165, 0
    v_mov_b32 v166, 0
    v_mov_b32 v167, 0
    v_mov_b32 v168, 0
    v_mov_b32 v169, 0
    v_mov_b32 v170, 0
    v_mov_b32 v171, 0
    v_mov_b32 v172, 0
    v_mov_b32 v173, 0
    v_mov_b32 v174, 0
    v_mov_b32 v175, 0
    v_mov_b32 v176, 0
    v_mov_b32 v177, 0
    v_mov_b32 v178, 0
    v_mov_b32 v179, 0
    v_mov_b32 v180, 0
    v_mov_b32 v181, 0
    v_mov_b32 v182, 0
    v_mov_b32 v183, 0
    v_mov_b32 v184, 0
    v_mov_b32 v185, 0
    v_mov_b32 v186, 0
    v_mov_b32 v187, 0
    v_mov_b32 v188, 0
    v_mov_b32 v189, 0
    v_mov_b32 v190, 0
    v_mov_b32 v191, 0
    v_mov_b32 v192, 0
    v_mov_b32 v193, 0
    v_mov_b32 v194, 0
    v_mov_b32 v195, 0
    v_mov_b32 v196, 0
    v_mov_b32 v197, 0
    v_mov_b32 v198, 0
    v_mov_b32 v199, 0
    v_mov_b32 v200, 0
    v_mov_b32 v201, 0
    v_mov_b32 v202, 0
    v_mov_b32 v203, 0
    v_mov_b32 v204, 0
    v_mov_b32 v205, 0
    v_mov_b32 v206, 0
    v_mov_b32 v207, 0
    v_add_u32 v7, 65536, v4
    v_add_u32 v8, 131072, v4
    s_and_b32 s55, s14, 3
    s_lshr_b32 s56, s14, 2
    s_waitcnt vmcnt(9)
    s_barrier
    ds_read_b128 v[96:99], v4 offset:0
    ds_read_b128 v[100:103], v4 offset:1024
    ds_read_b128 v[104:107], v4 offset:2048
    ds_read_b128 v[108:111], v4 offset:3072
    ds_read_b128 v[112:115], v4 offset:4096
    ds_read_b128 v[116:119], v4 offset:5120
    ds_read_b128 v[120:123], v4 offset:6144
    s_waitcnt lgkmcnt(0)
    v_mfma_f32_16x16x32_bf16 v[152:155], v[96:99], v[16:19], v[152:155]
    ds_read_b128 v[124:127], v4 offset:7168
    v_mfma_f32_16x16x32_bf16 v[156:159], v[100:103], v[16:19], v[156:159]
    ds_read_b128 v[128:131], v4 offset:8192
    s_add_u32 m0, s48, 57344
    s_add_u32 s49, s47, 884736
    buffer_load_dwordx4 v4, s[20:23], s49 offen offset:0 lds
    v_mfma_f32_16x16x32_bf16 v[160:163], v[104:107], v[16:19], v[160:163]
    ds_read_b128 v[132:135], v4 offset:9216
    v_mfma_f32_16x16x32_bf16 v[164:167], v[108:111], v[16:19], v[164:167]
    ds_read_b128 v[136:139], v4 offset:10240
    buffer_load_dwordx4 v4, s[20:23], s49 offen offset:1024 lds
    v_mfma_f32_16x16x32_bf16 v[168:171], v[112:115], v[16:19], v[168:171]
    ds_read_b128 v[140:143], v4 offset:11264
    v_mfma_f32_16x16x32_bf16 v[172:175], v[116:119], v[16:19], v[172:175]
    ds_read_b128 v[144:147], v4 offset:12288
    buffer_load_dwordx4 v4, s[20:23], s49 offen offset:2048 lds
    v_mfma_f32_16x16x32_bf16 v[176:179], v[120:123], v[16:19], v[176:179]
    ds_read_b128 v[148:151], v4 offset:13312
    s_cmp_lg_u32 s55, 0
    s_cbranch_scc1 k3cs_42
    s_cmp_lg_u32 s56, 0
    s_cbranch_scc1 k3ch_43
    v_mfma_f32_16x16x32_bf16 v[180:183], v[208:211], v[96:99], v[180:183]
    v_mfma_f32_16x16x32_bf16 v[184:187], v[208:211], v[100:103], v[184:187]
    v_mfma_f32_16x16x32_bf16 v[188:191], v[208:211], v[104:107], v[188:191]
    v_mfma_f32_16x16x32_bf16 v[192:195], v[208:211], v[108:111], v[192:195]
    s_branch k3cs_42
k3ch_43:
    v_mfma_f32_16x16x32_bf16 v[180:183], v[208:211], v[112:115], v[180:183]
    v_mfma_f32_16x16x32_bf16 v[184:187], v[208:211], v[116:119], v[184:187]
    v_mfma_f32_16x16x32_bf16 v[188:191], v[208:211], v[120:123], v[188:191]
k3cs_42:
    s_waitcnt lgkmcnt(0)
    v_mfma_f32_16x16x32_bf16 v[152:155], v[124:127], v[20:23], v[152:155]
    ds_read_b128 v[96:99], v4 offset:14336
    v_mfma_f32_16x16x32_bf16 v[156:159], v[128:131], v[20:23], v[156:159]
    ds_read_b128 v[100:103], v4 offset:15360
    s_add_u32 m0, m0, s54
    s_add_u32 s49, s49, s54
    buffer_load_dwordx4 v4, s[20:23], s49 offen offset:2048 lds
    v_mfma_f32_16x16x32_bf16 v[160:163], v[132:135], v[20:23], v[160:163]
    ds_read_b128 v[104:107], v4 offset:16384
    v_mfma_f32_16x16x32_bf16 v[164:167], v[136:139], v[20:23], v[164:167]
    ds_read_b128 v[108:111], v4 offset:17408
    s_movk_i32 s15, 8192
    buffer_load_dwordx4 v[48:51], v4, s[16:19], s15 offen offset:0
    v_mfma_f32_16x16x32_bf16 v[168:171], v[140:143], v[20:23], v[168:171]
    ds_read_b128 v[112:115], v4 offset:18432
    v_mfma_f32_16x16x32_bf16 v[172:175], v[144:147], v[20:23], v[172:175]
    ds_read_b128 v[116:119], v4 offset:19456
    s_movk_i32 s15, 8192
    buffer_load_dwordx4 v[52:55], v4, s[16:19], s15 offen offset:1024
    v_mfma_f32_16x16x32_bf16 v[176:179], v[148:151], v[20:23], v[176:179]
    ds_read_b128 v[120:123], v4 offset:20480
    s_cmp_lg_u32 s55, 1
    s_cbranch_scc1 k3cs_44
    s_cmp_lg_u32 s56, 0
    s_cbranch_scc1 k3ch_45
    v_mfma_f32_16x16x32_bf16 v[180:183], v[208:211], v[124:127], v[180:183]
    v_mfma_f32_16x16x32_bf16 v[184:187], v[208:211], v[128:131], v[184:187]
    v_mfma_f32_16x16x32_bf16 v[188:191], v[208:211], v[132:135], v[188:191]
    v_mfma_f32_16x16x32_bf16 v[192:195], v[208:211], v[136:139], v[192:195]
    s_branch k3cs_44
k3ch_45:
    v_mfma_f32_16x16x32_bf16 v[180:183], v[208:211], v[140:143], v[180:183]
    v_mfma_f32_16x16x32_bf16 v[184:187], v[208:211], v[144:147], v[184:187]
    v_mfma_f32_16x16x32_bf16 v[188:191], v[208:211], v[148:151], v[188:191]
k3cs_44:
    s_waitcnt lgkmcnt(0)
    v_mfma_f32_16x16x32_bf16 v[152:155], v[96:99], v[24:27], v[152:155]
    ds_read_b128 v[124:127], v4 offset:21504
    v_mfma_f32_16x16x32_bf16 v[156:159], v[100:103], v[24:27], v[156:159]
    ds_read_b128 v[128:131], v4 offset:22528
    s_movk_i32 s15, 8192
    buffer_load_dwordx4 v[56:59], v4, s[16:19], s15 offen offset:2048
    v_mfma_f32_16x16x32_bf16 v[160:163], v[104:107], v[24:27], v[160:163]
    ds_read_b128 v[132:135], v4 offset:23552
    v_mfma_f32_16x16x32_bf16 v[164:167], v[108:111], v[24:27], v[164:167]
    ds_read_b128 v[136:139], v4 offset:24576
    s_movk_i32 s15, 8192
    buffer_load_dwordx4 v[60:63], v4, s[16:19], s15 offen offset:3072
    v_mfma_f32_16x16x32_bf16 v[168:171], v[112:115], v[24:27], v[168:171]
    ds_read_b128 v[140:143], v4 offset:25600
    v_mfma_f32_16x16x32_bf16 v[172:175], v[116:119], v[24:27], v[172:175]
    ds_read_b128 v[144:147], v4 offset:26624
    v_mfma_f32_16x16x32_bf16 v[176:179], v[120:123], v[24:27], v[176:179]
    ds_read_b128 v[148:151], v4 offset:27648
    s_cmp_lg_u32 s55, 2
    s_cbranch_scc1 k3cs_46
    s_cmp_lg_u32 s56, 0
    s_cbranch_scc1 k3ch_47
    v_mfma_f32_16x16x32_bf16 v[180:183], v[208:211], v[96:99], v[180:183]
    v_mfma_f32_16x16x32_bf16 v[184:187], v[208:211], v[100:103], v[184:187]
    v_mfma_f32_16x16x32_bf16 v[188:191], v[208:211], v[104:107], v[188:191]
    v_mfma_f32_16x16x32_bf16 v[192:195], v[208:211], v[108:111], v[192:195]
    s_branch k3cs_46
k3ch_47:
    v_mfma_f32_16x16x32_bf16 v[180:183], v[208:211], v[112:115], v[180:183]
    v_mfma_f32_16x16x32_bf16 v[184:187], v[208:211], v[116:119], v[184:187]
    v_mfma_f32_16x16x32_bf16 v[188:191], v[208:211], v[120:123], v[188:191]
k3cs_46:
    s_waitcnt lgkmcnt(0)
    v_mfma_f32_16x16x32_bf16 v[152:155], v[124:127], v[28:31], v[152:155]
    v_mfma_f32_16x16x32_bf16 v[156:159], v[128:131], v[28:31], v[156:159]
    v_mfma_f32_16x16x32_bf16 v[160:163], v[132:135], v[28:31], v[160:163]
    v_mfma_f32_16x16x32_bf16 v[164:167], v[136:139], v[28:31], v[164:167]
    v_mfma_f32_16x16x32_bf16 v[168:171], v[140:143], v[28:31], v[168:171]
    v_mfma_f32_16x16x32_bf16 v[172:175], v[144:147], v[28:31], v[172:175]
    v_mfma_f32_16x16x32_bf16 v[176:179], v[148:151], v[28:31], v[176:179]
    s_cmp_lg_u32 s55, 3
    s_cbranch_scc1 k3cs_48
    s_cmp_lg_u32 s56, 0
    s_cbranch_scc1 k3ch_49
    v_mfma_f32_16x16x32_bf16 v[180:183], v[208:211], v[124:127], v[180:183]
    v_mfma_f32_16x16x32_bf16 v[184:187], v[208:211], v[128:131], v[184:187]
    v_mfma_f32_16x16x32_bf16 v[188:191], v[208:211], v[132:135], v[188:191]
    v_mfma_f32_16x16x32_bf16 v[192:195], v[208:211], v[136:139], v[192:195]
    s_branch k3cs_48
k3ch_49:
    v_mfma_f32_16x16x32_bf16 v[180:183], v[208:211], v[140:143], v[180:183]
    v_mfma_f32_16x16x32_bf16 v[184:187], v[208:211], v[144:147], v[184:187]
    v_mfma_f32_16x16x32_bf16 v[188:191], v[208:211], v[148:151], v[188:191]
k3cs_48:
    s_waitcnt vmcnt(9)
    s_barrier
    ds_read_b128 v[96:99], v4 offset:28672
    ds_read_b128 v[100:103], v4 offset:29696
    ds_read_b128 v[104:107], v4 offset:30720
    ds_read_b128 v[108:111], v4 offset:31744
    ds_read_b128 v[112:115], v4 offset:32768
    ds_read_b128 v[116:119], v4 offset:33792
    ds_read_b128 v[120:123], v4 offset:34816
    s_waitcnt lgkmcnt(0)
    v_mfma_f32_16x16x32_bf16 v[152:155], v[96:99], v[32:35], v[152:155]
    ds_read_b128 v[124:127], v4 offset:35840
    v_mfma_f32_16x16x32_bf16 v[156:159], v[100:103], v[32:35], v[156:159]
    ds_read_b128 v[128:131], v4 offset:36864
    s_add_u32 m0, s48, 86016
    s_add_u32 s49, s47, 1327104
    buffer_load_dwordx4 v4, s[20:23], s49 offen offset:0 lds
    v_mfma_f32_16x16x32_bf16 v[160:163], v[104:107], v[32:35], v[160:163]
    ds_read_b128 v[132:135], v4 offset:37888
    v_mfma_f32_16x16x32_bf16 v[164:167], v[108:111], v[32:35], v[164:167]
    ds_read_b128 v[136:139], v4 offset:38912
    buffer_load_dwordx4 v4, s[20:23], s49 offen offset:1024 lds
    v_mfma_f32_16x16x32_bf16 v[168:171], v[112:115], v[32:35], v[168:171]
    ds_read_b128 v[140:143], v4 offset:39936
    v_mfma_f32_16x16x32_bf16 v[172:175], v[116:119], v[32:35], v[172:175]
    ds_read_b128 v[144:147], v4 offset:40960
    buffer_load_dwordx4 v4, s[20:23], s49 offen offset:2048 lds
    v_mfma_f32_16x16x32_bf16 v[176:179], v[120:123], v[32:35], v[176:179]
    ds_read_b128 v[148:151], v4 offset:41984
    s_cmp_lg_u32 s55, 0
    s_cbranch_scc1 k3cs_50
    s_cmp_lg_u32 s56, 0
    s_cbranch_scc1 k3ch_51
    v_mfma_f32_16x16x32_bf16 v[180:183], v[208:211], v[96:99], v[180:183]
    v_mfma_f32_16x16x32_bf16 v[184:187], v[208:211], v[100:103], v[184:187]
    v_mfma_f32_16x16x32_bf16 v[188:191], v[208:211], v[104:107], v[188:191]
    v_mfma_f32_16x16x32_bf16 v[192:195], v[208:211], v[108:111], v[192:195]
    s_branch k3cs_50
k3ch_51:
    v_mfma_f32_16x16x32_bf16 v[180:183], v[208:211], v[112:115], v[180:183]
    v_mfma_f32_16x16x32_bf16 v[184:187], v[208:211], v[116:119], v[184:187]
    v_mfma_f32_16x16x32_bf16 v[188:191], v[208:211], v[120:123], v[188:191]
k3cs_50:
    s_waitcnt lgkmcnt(0)
    v_mfma_f32_16x16x32_bf16 v[152:155], v[124:127], v[36:39], v[152:155]
    ds_read_b128 v[96:99], v4 offset:43008
    v_mfma_f32_16x16x32_bf16 v[156:159], v[128:131], v[36:39], v[156:159]
    ds_read_b128 v[100:103], v4 offset:44032
    s_add_u32 m0, m0, s54
    s_add_u32 s49, s49, s54
    buffer_load_dwordx4 v4, s[20:23], s49 offen offset:2048 lds
    v_mfma_f32_16x16x32_bf16 v[160:163], v[132:135], v[36:39], v[160:163]
    ds_read_b128 v[104:107], v4 offset:45056
    v_mfma_f32_16x16x32_bf16 v[164:167], v[136:139], v[36:39], v[164:167]
    ds_read_b128 v[108:111], v4 offset:46080
    s_movk_i32 s15, 12288
    buffer_load_dwordx4 v[64:67], v4, s[16:19], s15 offen offset:0
    v_mfma_f32_16x16x32_bf16 v[168:171], v[140:143], v[36:39], v[168:171]
    ds_read_b128 v[112:115], v4 offset:47104
    v_mfma_f32_16x16x32_bf16 v[172:175], v[144:147], v[36:39], v[172:175]
    ds_read_b128 v[116:119], v4 offset:48128
    s_movk_i32 s15, 12288
    buffer_load_dwordx4 v[68:71], v4, s[16:19], s15 offen offset:1024
    v_mfma_f32_16x16x32_bf16 v[176:179], v[148:151], v[36:39], v[176:179]
    ds_read_b128 v[120:123], v4 offset:49152
    s_cmp_lg_u32 s55, 1
    s_cbranch_scc1 k3cs_52
    s_cmp_lg_u32 s56, 0
    s_cbranch_scc1 k3ch_53
    v_mfma_f32_16x16x32_bf16 v[180:183], v[208:211], v[124:127], v[180:183]
    v_mfma_f32_16x16x32_bf16 v[184:187], v[208:211], v[128:131], v[184:187]
    v_mfma_f32_16x16x32_bf16 v[188:191], v[208:211], v[132:135], v[188:191]
    v_mfma_f32_16x16x32_bf16 v[192:195], v[208:211], v[136:139], v[192:195]
    s_branch k3cs_52
k3ch_53:
    v_mfma_f32_16x16x32_bf16 v[180:183], v[208:211], v[140:143], v[180:183]
    v_mfma_f32_16x16x32_bf16 v[184:187], v[208:211], v[144:147], v[184:187]
    v_mfma_f32_16x16x32_bf16 v[188:191], v[208:211], v[148:151], v[188:191]
k3cs_52:
    s_waitcnt lgkmcnt(0)
    v_mfma_f32_16x16x32_bf16 v[152:155], v[96:99], v[40:43], v[152:155]
    ds_read_b128 v[124:127], v4 offset:50176
    v_mfma_f32_16x16x32_bf16 v[156:159], v[100:103], v[40:43], v[156:159]
    ds_read_b128 v[128:131], v4 offset:51200
    s_movk_i32 s15, 12288
    buffer_load_dwordx4 v[72:75], v4, s[16:19], s15 offen offset:2048
    v_mfma_f32_16x16x32_bf16 v[160:163], v[104:107], v[40:43], v[160:163]
    ds_read_b128 v[132:135], v4 offset:52224
    v_mfma_f32_16x16x32_bf16 v[164:167], v[108:111], v[40:43], v[164:167]
    ds_read_b128 v[136:139], v4 offset:53248
    s_movk_i32 s15, 12288
    buffer_load_dwordx4 v[76:79], v4, s[16:19], s15 offen offset:3072
    v_mfma_f32_16x16x32_bf16 v[168:171], v[112:115], v[40:43], v[168:171]
    ds_read_b128 v[140:143], v4 offset:54272
    v_mfma_f32_16x16x32_bf16 v[172:175], v[116:119], v[40:43], v[172:175]
    ds_read_b128 v[144:147], v4 offset:55296
    v_mfma_f32_16x16x32_bf16 v[176:179], v[120:123], v[40:43], v[176:179]
    ds_read_b128 v[148:151], v4 offset:56320
    s_cmp_lg_u32 s55, 2
    s_cbranch_scc1 k3cs_54
    s_cmp_lg_u32 s56, 0
    s_cbranch_scc1 k3ch_55
    v_mfma_f32_16x16x32_bf16 v[180:183], v[208:211], v[96:99], v[180:183]
    v_mfma_f32_16x16x32_bf16 v[184:187], v[208:211], v[100:103], v[184:187]
    v_mfma_f32_16x16x32_bf16 v[188:191], v[208:211], v[104:107], v[188:191]
    v_mfma_f32_16x16x32_bf16 v[192:195], v[208:211], v[108:111], v[192:195]
    s_branch k3cs_54
k3ch_55:
    v_mfma_f32_16x16x32_bf16 v[180:183], v[208:211], v[112:115], v[180:183]
    v_mfma_f32_16x16x32_bf16 v[184:187], v[208:211], v[116:119], v[184:187]
    v_mfma_f32_16x16x32_bf16 v[188:191], v[208:211], v[120:123], v[188:191]
k3cs_54:
    s_waitcnt lgkmcnt(0)
    v_mfma_f32_16x16x32_bf16 v[152:155], v[124:127], v[44:47], v[152:155]
    v_mfma_f32_16x16x32_bf16 v[156:159], v[128:131], v[44:47], v[156:159]
    v_mfma_f32_16x16x32_bf16 v[160:163], v[132:135], v[44:47], v[160:163]
    v_mfma_f32_16x16x32_bf16 v[164:167], v[136:139], v[44:47], v[164:167]
    v_mfma_f32_16x16x32_bf16 v[168:171], v[140:143], v[44:47], v[168:171]
    v_mfma_f32_16x16x32_bf16 v[172:175], v[144:147], v[44:47], v[172:175]
    v_mfma_f32_16x16x32_bf16 v[176:179], v[148:151], v[44:47], v[176:179]
    s_cmp_lg_u32 s55, 3
    s_cbranch_scc1 k3cs_56
    s_cmp_lg_u32 s56, 0
    s_cbranch_scc1 k3ch_57
    v_mfma_f32_16x16x32_bf16 v[180:183], v[208:211], v[124:127], v[180:183]
    v_mfma_f32_16x16x32_bf16 v[184:187], v[208:211], v[128:131], v[184:187]
    v_mfma_f32_16x16x32_bf16 v[188:191], v[208:211], v[132:135], v[188:191]
    v_mfma_f32_16x16x32_bf16 v[192:195], v[208:211], v[136:139], v[192:195]
    s_branch k3cs_56
k3ch_57:
    v_mfma_f32_16x16x32_bf16 v[180:183], v[208:211], v[140:143], v[180:183]
    v_mfma_f32_16x16x32_bf16 v[184:187], v[208:211], v[144:147], v[184:187]
    v_mfma_f32_16x16x32_bf16 v[188:191], v[208:211], v[148:151], v[188:191]
k3cs_56:
    s_waitcnt vmcnt(8)
    s_barrier
    ds_read_b128 v[96:99], v4 offset:57344
    ds_read_b128 v[100:103], v4 offset:58368
    ds_read_b128 v[104:107], v4 offset:59392
    ds_read_b128 v[108:111], v4 offset:60416
    ds_read_b128 v[112:115], v4 offset:61440
    ds_read_b128 v[116:119], v4 offset:62464
    ds_read_b128 v[120:123], v4 offset:63488
    s_waitcnt lgkmcnt(0)
    v_mfma_f32_16x16x32_bf16 v[152:155], v[96:99], v[48:51], v[152:155]
    ds_read_b128 v[124:127], v4 offset:64512
    v_mfma_f32_16x16x32_bf16 v[156:159], v[100:103], v[48:51], v[156:159]
    ds_read_b128 v[128:131], v7 offset:0
    s_add_u32 m0, s48, 114688
    s_add_u32 s49, s47, 1769472
    buffer_load_dwordx4 v4, s[20:23], s49 offen offset:0 lds
    v_mfma_f32_16x16x32_bf16 v[160:163], v[104:107], v[48:51], v[160:163]
    ds_read_b128 v[132:135], v7 offset:1024
    v_mfma_f32_16x16x32_bf16 v[164:167], v[108:111], v[48:51], v[164:167]
    ds_read_b128 v[136:139], v7 offset:2048
    buffer_load_dwordx4 v4, s[20:23], s49 offen offset:1024 lds
    v_mfma_f32_16x16x32_bf16 v[168:171], v[112:115], v[48:51], v[168:171]
    ds_read_b128 v[140:143], v7 offset:3072
    v_mfma_f32_16x16x32_bf16 v[172:175], v[116:119], v[48:51], v[172:175]
    ds_read_b128 v[144:147], v7 offset:4096
    buffer_load_dwordx4 v4, s[20:23], s49 offen offset:2048 lds
    v_mfma_f32_16x16x32_bf16 v[176:179], v[120:123], v[48:51], v[176:179]
    ds_read_b128 v[148:151], v7 offset:5120
    s_cmp_lg_u32 s55, 0
    s_cbranch_scc1 k3cs_58
    s_cmp_lg_u32 s56, 0
    s_cbranch_scc1 k3ch_59
    v_mfma_f32_16x16x32_bf16 v[180:183], v[208:211], v[96:99], v[180:183]
    v_mfma_f32_16x16x32_bf16 v[184:187], v[208:211], v[100:103], v[184:187]
    v_mfma_f32_16x16x32_bf16 v[188:191], v[208:211], v[104:107], v[188:191]
    v_mfma_f32_16x16x32_bf16 v[192:195], v[208:211], v[108:111], v[192:195]
    s_branch k3cs_58
k3ch_59:
    v_mfma_f32_16x16x32_bf16 v[180:183], v[208:211], v[112:115], v[180:183]
    v_mfma_f32_16x16x32_bf16 v[184:187], v[208:211], v[116:119], v[184:187]
    v_mfma_f32_16x16x32_bf16 v[188:191], v[208:211], v[120:123], v[188:191]
k3cs_58:
    s_waitcnt lgkmcnt(0)
    v_mfma_f32_16x16x32_bf16 v[152:155], v[124:127], v[52:55], v[152:155]
    ds_read_b128 v[96:99], v7 offset:6144
    v_mfma_f32_16x16x32_bf16 v[156:159], v[128:131], v[52:55], v[156:159]
    ds_read_b128 v[100:103], v7 offset:7168
    s_add_u32 m0, m0, s54
    s_add_u32 s49, s49, s54
    buffer_load_dwordx4 v4, s[20:23], s49 offen offset:2048 lds
    v_mfma_f32_16x16x32_bf16 v[160:163], v[132:135], v[52:55], v[160:163]
    ds_read_b128 v[104:107], v7 offset:8192
    v_mfma_f32_16x16x32_bf16 v[164:167], v[136:139], v[52:55], v[164:167]
    ds_read_b128 v[108:111], v7 offset:9216
    s_movk_i32 s15, 16384
    buffer_load_dwordx4 v[80:83], v4, s[16:19], s15 offen offset:0
    v_mfma_f32_16x16x32_bf16 v[168:171], v[140:143], v[52:55], v[168:171]
    ds_read_b128 v[112:115], v7 offset:10240
    v_mfma_f32_16x16x32_bf16 v[172:175], v[144:147], v[52:55], v[172:175]
    ds_read_b128 v[116:119], v7 offset:11264
    s_movk_i32 s15, 16384
    buffer_load_dwordx4 v[84:87], v4, s[16:19], s15 offen offset:1024
    v_mfma_f32_16x16x32_bf16 v[176:179], v[148:151], v[52:55], v[176:179]
    ds_read_b128 v[120:123], v7 offset:12288
    s_cmp_lg_u32 s55, 1
    s_cbranch_scc1 k3cs_60
    s_cmp_lg_u32 s56, 0
    s_cbranch_scc1 k3ch_61
    v_mfma_f32_16x16x32_bf16 v[180:183], v[208:211], v[124:127], v[180:183]
    v_mfma_f32_16x16x32_bf16 v[184:187], v[208:211], v[128:131], v[184:187]
    v_mfma_f32_16x16x32_bf16 v[188:191], v[208:211], v[132:135], v[188:191]
    v_mfma_f32_16x16x32_bf16 v[192:195], v[208:211], v[136:139], v[192:195]
    s_branch k3cs_60
k3ch_61:
    v_mfma_f32_16x16x32_bf16 v[180:183], v[208:211], v[140:143], v[180:183]
    v_mfma_f32_16x16x32_bf16 v[184:187], v[208:211], v[144:147], v[184:187]
    v_mfma_f32_16x16x32_bf16 v[188:191], v[208:211], v[148:151], v[188:191]
k3cs_60:
    s_waitcnt lgkmcnt(0)
    v_mfma_f32_16x16x32_bf16 v[152:155], v[96:99], v[56:59], v[152:155]
    ds_read_b128 v[124:127], v7 offset:13312
    v_mfma_f32_16x16x32_bf16 v[156:159], v[100:103], v[56:59], v[156:159]
    ds_read_b128 v[128:131], v7 offset:14336
    s_movk_i32 s15, 16384
    buffer_load_dwordx4 v[88:91], v4, s[16:19], s15 offen offset:2048
    v_mfma_f32_16x16x32_bf16 v[160:163], v[104:107], v[56:59], v[160:163]
    ds_read_b128 v[132:135], v7 offset:15360
    v_mfma_f32_16x16x32_bf16 v[164:167], v[108:111], v[56:59], v[164:167]
    ds_read_b128 v[136:139], v7 offset:16384
    s_movk_i32 s15, 16384
    buffer_load_dwordx4 v[92:95], v4, s[16:19], s15 offen offset:3072
    v_mfma_f32_16x16x32_bf16 v[168:171], v[112:115], v[56:59], v[168:171]
    ds_read_b128 v[140:143], v7 offset:17408
    v_mfma_f32_16x16x32_bf16 v[172:175], v[116:119], v[56:59], v[172:175]
    ds_read_b128 v[144:147], v7 offset:18432
    v_mfma_f32_16x16x32_bf16 v[176:179], v[120:123], v[56:59], v[176:179]
    ds_read_b128 v[148:151], v7 offset:19456
    s_cmp_lg_u32 s55, 2
    s_cbranch_scc1 k3cs_62
    s_cmp_lg_u32 s56, 0
    s_cbranch_scc1 k3ch_63
    v_mfma_f32_16x16x32_bf16 v[180:183], v[208:211], v[96:99], v[180:183]
    v_mfma_f32_16x16x32_bf16 v[184:187], v[208:211], v[100:103], v[184:187]
    v_mfma_f32_16x16x32_bf16 v[188:191], v[208:211], v[104:107], v[188:191]
    v_mfma_f32_16x16x32_bf16 v[192:195], v[208:211], v[108:111], v[192:195]
    s_branch k3cs_62
k3ch_63:
    v_mfma_f32_16x16x32_bf16 v[180:183], v[208:211], v[112:115], v[180:183]
    v_mfma_f32_16x16x32_bf16 v[184:187], v[208:211], v[116:119], v[184:187]
    v_mfma_f32_16x16x32_bf16 v[188:191], v[208:211], v[120:123], v[188:191]
k3cs_62:
    s_waitcnt lgkmcnt(0)
    v_mfma_f32_16x16x32_bf16 v[152:155], v[124:127], v[60:63], v[152:155]
    v_mfma_f32_16x16x32_bf16 v[156:159], v[128:131], v[60:63], v[156:159]
    v_mfma_f32_16x16x32_bf16 v[160:163], v[132:135], v[60:63], v[160:163]
    v_mfma_f32_16x16x32_bf16 v[164:167], v[136:139], v[60:63], v[164:167]
    v_mfma_f32_16x16x32_bf16 v[168:171], v[140:143], v[60:63], v[168:171]
    v_mfma_f32_16x16x32_bf16 v[172:175], v[144:147], v[60:63], v[172:175]
    v_mfma_f32_16x16x32_bf16 v[176:179], v[148:151], v[60:63], v[176:179]
    s_cmp_lg_u32 s55, 3
    s_cbranch_scc1 k3cs_64
    s_cmp_lg_u32 s56, 0
    s_cbranch_scc1 k3ch_65
    v_mfma_f32_16x16x32_bf16 v[180:183], v[208:211], v[124:127], v[180:183]
    v_mfma_f32_16x16x32_bf16 v[184:187], v[208:211], v[128:131], v[184:187]
    v_mfma_f32_16x16x32_bf16 v[188:191], v[208:211], v[132:135], v[188:191]
    v_mfma_f32_16x16x32_bf16 v[192:195], v[208:211], v[136:139], v[192:195]
    s_branch k3cs_64
k3ch_65:
    v_mfma_f32_16x16x32_bf16 v[180:183], v[208:211], v[140:143], v[180:183]
    v_mfma_f32_16x16x32_bf16 v[184:187], v[208:211], v[144:147], v[184:187]
    v_mfma_f32_16x16x32_bf16 v[188:191], v[208:211], v[148:151], v[188:191]
k3cs_64:
    s_waitcnt vmcnt(8)
    s_barrier
    ds_read_b128 v[96:99], v7 offset:20480
    ds_read_b128 v[100:103], v7 offset:21504
    ds_read_b128 v[104:107], v7 offset:22528
    ds_read_b128 v[108:111], v7 offset:23552
    ds_read_b128 v[112:115], v7 offset:24576
    ds_read_b128 v[116:119], v7 offset:25600
    ds_read_b128 v[120:123], v7 offset:26624
    s_waitcnt lgkmcnt(0)
    v_mfma_f32_16x16x32_bf16 v[152:155], v[96:99], v[64:67], v[152:155]
    ds_read_b128 v[124:127], v7 offset:27648
    v_mfma_f32_16x16x32_bf16 v[156:159], v[100:103], v[64:67], v[156:159]
    ds_read_b128 v[128:131], v7 offset:28672
    v_mfma_f32_16x16x32_bf16 v[160:163], v[104:107], v[64:67], v[160:163]
    ds_read_b128 v[132:135], v7 offset:29696
    v_mfma_f32_16x16x32_bf16 v[164:167], v[108:111], v[64:67], v[164:167]
    ds_read_b128 v[136:139], v7 offset:30720
    v_mfma_f32_16x16x32_bf16 v[168:171], v[112:115], v[64:67], v[168:171]
    ds_read_b128 v[140:143], v7 offset:31744
    v_mfma_f32_16x16x32_bf16 v[172:175], v[116:119], v[64:67], v[172:175]
    ds_read_b128 v[144:147], v7 offset:32768
    v_mfma_f32_16x16x32_bf16 v[176:179], v[120:123], v[64:67], v[176:179]
    ds_read_b128 v[148:151], v7 offset:33792
    s_cmp_lg_u32 s55, 0
    s_cbranch_scc1 k3cs_66
    s_cmp_lg_u32 s56, 0
    s_cbranch_scc1 k3ch_67
    v_mfma_f32_16x16x32_bf16 v[180:183], v[208:211], v[96:99], v[180:183]
    v_mfma_f32_16x16x32_bf16 v[184:187], v[208:211], v[100:103], v[184:187]
    v_mfma_f32_16x16x32_bf16 v[188:191], v[208:211], v[104:107], v[188:191]
    v_mfma_f32_16x16x32_bf16 v[192:195], v[208:211], v[108:111], v[192:195]
    s_branch k3cs_66
k3ch_67:
    v_mfma_f32_16x16x32_bf16 v[180:183], v[208:211], v[112:115], v[180:183]
    v_mfma_f32_16x16x32_bf16 v[184:187], v[208:211], v[116:119], v[184:187]
    v_mfma_f32_16x16x32_bf16 v[188:191], v[208:211], v[120:123], v[188:191]
k3cs_66:
    s_waitcnt lgkmcnt(0)
    v_mfma_f32_16x16x32_bf16 v[152:155], v[124:127], v[68:71], v[152:155]
    ds_read_b128 v[96:99], v7 offset:34816
    v_mfma_f32_16x16x32_bf16 v[156:159], v[128:131], v[68:71], v[156:159]
    ds_read_b128 v[100:103], v7 offset:35840
    v_mfma_f32_16x16x32_bf16 v[160:163], v[132:135], v[68:71], v[160:163]
    ds_read_b128 v[104:107], v7 offset:36864
    v_mfma_f32_16x16x32_bf16 v[164:167], v[136:139], v[68:71], v[164:167]
    ds_read_b128 v[108:111], v7 offset:37888
    v_mfma_f32_16x16x32_bf16 v[168:171], v[140:143], v[68:71], v[168:171]
    ds_read_b128 v[112:115], v7 offset:38912
    v_mfma_f32_16x16x32_bf16 v[172:175], v[144:147], v[68:71], v[172:175]
    ds_read_b128 v[116:119], v7 offset:39936
    v_mfma_f32_16x16x32_bf16 v[176:179], v[148:151], v[68:71], v[176:179]
    ds_read_b128 v[120:123], v7 offset:40960
    s_cmp_lg_u32 s55, 1
    s_cbranch_scc1 k3cs_68
    s_cmp_lg_u32 s56, 0
    s_cbranch_scc1 k3ch_69
    v_mfma_f32_16x16x32_bf16 v[180:183], v[208:211], v[124:127], v[180:183]
    v_mfma_f32_16x16x32_bf16 v[184:187], v[208:211], v[128:131], v[184:187]
    v_mfma_f32_16x16x32_bf16 v[188:191], v[208:211], v[132:135], v[188:191]
    v_mfma_f32_16x16x32_bf16 v[192:195], v[208:211], v[136:139], v[192:195]
    s_branch k3cs_68
k3ch_69:
    v_mfma_f32_16x16x32_bf16 v[180:183], v[208:211], v[140:143], v[180:183]
    v_mfma_f32_16x16x32_bf16 v[184:187], v[208:211], v[144:147], v[184:187]
    v_mfma_f32_16x16x32_bf16 v[188:191], v[208:211], v[148:151], v[188:191]
k3cs_68:
    s_waitcnt lgkmcnt(0)
    v_mfma_f32_16x16x32_bf16 v[152:155], v[96:99], v[72:75], v[152:155]
    ds_read_b128 v[124:127], v7 offset:41984
    v_mfma_f32_16x16x32_bf16 v[156:159], v[100:103], v[72:75], v[156:159]
    ds_read_b128 v[128:131], v7 offset:43008
    v_mfma_f32_16x16x32_bf16 v[160:163], v[104:107], v[72:75], v[160:163]
    ds_read_b128 v[132:135], v7 offset:44032
    v_mfma_f32_16x16x32_bf16 v[164:167], v[108:111], v[72:75], v[164:167]
    ds_read_b128 v[136:139], v7 offset:45056
    v_mfma_f32_16x16x32_bf16 v[168:171], v[112:115], v[72:75], v[168:171]
    ds_read_b128 v[140:143], v7 offset:46080
    v_mfma_f32_16x16x32_bf16 v[172:175], v[116:119], v[72:75], v[172:175]
    ds_read_b128 v[144:147], v7 offset:47104
    v_mfma_f32_16x16x32_bf16 v[176:179], v[120:123], v[72:75], v[176:179]
    ds_read_b128 v[148:151], v7 offset:48128
    s_cmp_lg_u32 s55, 2
    s_cbranch_scc1 k3cs_70
    s_cmp_lg_u32 s56, 0
    s_cbranch_scc1 k3ch_71
    v_mfma_f32_16x16x32_bf16 v[180:183], v[208:211], v[96:99], v[180:183]
    v_mfma_f32_16x16x32_bf16 v[184:187], v[208:211], v[100:103], v[184:187]
    v_mfma_f32_16x16x32_bf16 v[188:191], v[208:211], v[104:107], v[188:191]
    v_mfma_f32_16x16x32_bf16 v[192:195], v[208:211], v[108:111], v[192:195]
    s_branch k3cs_70
k3ch_71:
    v_mfma_f32_16x16x32_bf16 v[180:183], v[208:211], v[112:115], v[180:183]
    v_mfma_f32_16x16x32_bf16 v[184:187], v[208:211], v[116:119], v[184:187]
    v_mfma_f32_16x16x32_bf16 v[188:191], v[208:211], v[120:123], v[188:191]
k3cs_70:
    s_waitcnt lgkmcnt(0)
    v_mfma_f32_16x16x32_bf16 v[152:155], v[124:127], v[76:79], v[152:155]
    v_mfma_f32_16x16x32_bf16 v[156:159], v[128:131], v[76:79], v[156:159]
    v_mfma_f32_16x16x32_bf16 v[160:163], v[132:135], v[76:79], v[160:163]
    v_mfma_f32_16x16x32_bf16 v[164:167], v[136:139], v[76:79], v[164:167]
    v_mfma_f32_16x16x32_bf16 v[168:171], v[140:143], v[76:79], v[168:171]
    v_mfma_f32_16x16x32_bf16 v[172:175], v[144:147], v[76:79], v[172:175]
    v_mfma_f32_16x16x32_bf16 v[176:179], v[148:151], v[76:79], v[176:179]
    s_cmp_lg_u32 s55, 3
    s_cbranch_scc1 k3cs_72
    s_cmp_lg_u32 s56, 0
    s_cbranch_scc1 k3ch_73
    v_mfma_f32_16x16x32_bf16 v[180:183], v[208:211], v[124:127], v[180:183]
    v_mfma_f32_16x16x32_bf16 v[184:187], v[208:211], v[128:131], v[184:187]
    v_mfma_f32_16x16x32_bf16 v[188:191], v[208:211], v[132:135], v[188:191]
    v_mfma_f32_16x16x32_bf16 v[192:195], v[208:211], v[136:139], v[192:195]
    s_branch k3cs_72
k3ch_73:
    v_mfma_f32_16x16x32_bf16 v[180:183], v[208:211], v[140:143], v[180:183]
    v_mfma_f32_16x16x32_bf16 v[184:187], v[208:211], v[144:147], v[184:187]
    v_mfma_f32_16x16x32_bf16 v[188:191], v[208:211], v[148:151], v[188:191]
k3cs_72:
    s_waitcnt vmcnt(0)
    s_barrier
    ds_read_b128 v[96:99], v7 offset:49152
    ds_read_b128 v[100:103], v7 offset:50176
    ds_read_b128 v[104:107], v7 offset:51200
    ds_read_b128 v[108:111], v7 offset:52224
    ds_read_b128 v[112:115], v7 offset:53248
    ds_read_b128 v[116:119], v7 offset:54272
    ds_read_b128 v[120:123], v7 offset:55296
    s_waitcnt lgkmcnt(0)
    v_mfma_f32_16x16x32_bf16 v[152:155], v[96:99], v[80:83], v[152:155]
    ds_read_b128 v[124:127], v7 offset:56320
    v_mfma_f32_16x16x32_bf16 v[156:159], v[100:103], v[80:83], v[156:159]
    ds_read_b128 v[128:131], v7 offset:57344
    v_mfma_f32_16x16x32_bf16 v[160:163], v[104:107], v[80:83], v[160:163]
    ds_read_b128 v[132:135], v7 offset:58368
    v_mfma_f32_16x16x32_bf16 v[164:167], v[108:111], v[80:83], v[164:167]
    ds_read_b128 v[136:139], v7 offset:59392
    v_mfma_f32_16x16x32_bf16 v[168:171], v[112:115], v[80:83], v[168:171]
    ds_read_b128 v[140:143], v7 offset:60416
    v_mfma_f32_16x16x32_bf16 v[172:175], v[116:119], v[80:83], v[172:175]
    ds_read_b128 v[144:147], v7 offset:61440
    v_mfma_f32_16x16x32_bf16 v[176:179], v[120:123], v[80:83], v[176:179]
    ds_read_b128 v[148:151], v7 offset:62464
    s_cmp_lg_u32 s55, 0
    s_cbranch_scc1 k3cs_74
    s_cmp_lg_u32 s56, 0
    s_cbranch_scc1 k3ch_75
    v_mfma_f32_16x16x32_bf16 v[180:183], v[208:211], v[96:99], v[180:183]
    v_mfma_f32_16x16x32_bf16 v[184:187], v[208:211], v[100:103], v[184:187]
    v_mfma_f32_16x16x32_bf16 v[188:191], v[208:211], v[104:107], v[188:191]
    v_mfma_f32_16x16x32_bf16 v[192:195], v[208:211], v[108:111], v[192:195]
    s_branch k3cs_74
k3ch_75:
    v_mfma_f32_16x16x32_bf16 v[180:183], v[208:211], v[112:115], v[180:183]
    v_mfma_f32_16x16x32_bf16 v[184:187], v[208:211], v[116:119], v[184:187]
    v_mfma_f32_16x16x32_bf16 v[188:191], v[208:211], v[120:123], v[188:191]
k3cs_74:
    s_waitcnt lgkmcnt(0)
    v_mfma_f32_16x16x32_bf16 v[152:155], v[124:127], v[84:87], v[152:155]
    ds_read_b128 v[96:99], v7 offset:63488
    v_mfma_f32_16x16x32_bf16 v[156:159], v[128:131], v[84:87], v[156:159]
    ds_read_b128 v[100:103], v7 offset:64512
    v_mfma_f32_16x16x32_bf16 v[160:163], v[132:135], v[84:87], v[160:163]
    ds_read_b128 v[104:107], v8 offset:0
    v_mfma_f32_16x16x32_bf16 v[164:167], v[136:139], v[84:87], v[164:167]
    ds_read_b128 v[108:111], v8 offset:1024
    v_mfma_f32_16x16x32_bf16 v[168:171], v[140:143], v[84:87], v[168:171]
    ds_read_b128 v[112:115], v8 offset:2048
    v_mfma_f32_16x16x32_bf16 v[172:175], v[144:147], v[84:87], v[172:175]
    ds_read_b128 v[116:119], v8 offset:3072
    v_mfma_f32_16x16x32_bf16 v[176:179], v[148:151], v[84:87], v[176:179]
    ds_read_b128 v[120:123], v8 offset:4096
    s_cmp_lg_u32 s55, 1
    s_cbranch_scc1 k3cs_76
    s_cmp_lg_u32 s56, 0
    s_cbranch_scc1 k3ch_77
    v_mfma_f32_16x16x32_bf16 v[180:183], v[208:211], v[124:127], v[180:183]
    v_mfma_f32_16x16x32_bf16 v[184:187], v[208:211], v[128:131], v[184:187]
    v_mfma_f32_16x16x32_bf16 v[188:191], v[208:211], v[132:135], v[188:191]
    v_mfma_f32_16x16x32_bf16 v[192:195], v[208:211], v[136:139], v[192:195]
    s_branch k3cs_76
k3ch_77:
    v_mfma_f32_16x16x32_bf16 v[180:183], v[208:211], v[140:143], v[180:183]
    v_mfma_f32_16x16x32_bf16 v[184:187], v[208:211], v[144:147], v[184:187]
    v_mfma_f32_16x16x32_bf16 v[188:191], v[208:211], v[148:151], v[188:191]
k3cs_76:
    s_waitcnt lgkmcnt(0)
    v_mfma_f32_16x16x32_bf16 v[152:155], v[96:99], v[88:91], v[152:155]
    ds_read_b128 v[124:127], v8 offset:5120
    v_mfma_f32_16x16x32_bf16 v[156:159], v[100:103], v[88:91], v[156:159]
    ds_read_b128 v[128:131], v8 offset:6144
    v_mfma_f32_16x16x32_bf16 v[160:163], v[104:107], v[88:91], v[160:163]
    ds_read_b128 v[132:135], v8 offset:7168
    v_mfma_f32_16x16x32_bf16 v[164:167], v[108:111], v[88:91], v[164:167]
    ds_read_b128 v[136:139], v8 offset:8192
    v_mfma_f32_16x16x32_bf16 v[168:171], v[112:115], v[88:91], v[168:171]
    ds_read_b128 v[140:143], v8 offset:9216
    v_mfma_f32_16x16x32_bf16 v[172:175], v[116:119], v[88:91], v[172:175]
    ds_read_b128 v[144:147], v8 offset:10240
    v_mfma_f32_16x16x32_bf16 v[176:179], v[120:123], v[88:91], v[176:179]
    ds_read_b128 v[148:151], v8 offset:11264
    s_cmp_lg_u32 s55, 2
    s_cbranch_scc1 k3cs_78
    s_cmp_lg_u32 s56, 0
    s_cbranch_scc1 k3ch_79
    v_mfma_f32_16x16x32_bf16 v[180:183], v[208:211], v[96:99], v[180:183]
    v_mfma_f32_16x16x32_bf16 v[184:187], v[208:211], v[100:103], v[184:187]
    v_mfma_f32_16x16x32_bf16 v[188:191], v[208:211], v[104:107], v[188:191]
    v_mfma_f32_16x16x32_bf16 v[192:195], v[208:211], v[108:111], v[192:195]
    s_branch k3cs_78
k3ch_79:
    v_mfma_f32_16x16x32_bf16 v[180:183], v[208:211], v[112:115], v[180:183]
    v_mfma_f32_16x16x32_bf16 v[184:187], v[208:211], v[116:119], v[184:187]
    v_mfma_f32_16x16x32_bf16 v[188:191], v[208:211], v[120:123], v[188:191]
k3cs_78:
    s_waitcnt lgkmcnt(0)
    v_mfma_f32_16x16x32_bf16 v[152:155], v[124:127], v[92:95], v[152:155]
    v_mfma_f32_16x16x32_bf16 v[156:159], v[128:131], v[92:95], v[156:159]
    v_mfma_f32_16x16x32_bf16 v[160:163], v[132:135], v[92:95], v[160:163]
    v_mfma_f32_16x16x32_bf16 v[164:167], v[136:139], v[92:95], v[164:167]
    v_mfma_f32_16x16x32_bf16 v[168:171], v[140:143], v[92:95], v[168:171]
    v_mfma_f32_16x16x32_bf16 v[172:175], v[144:147], v[92:95], v[172:175]
    v_mfma_f32_16x16x32_bf16 v[176:179], v[148:151], v[92:95], v[176:179]
    s_cmp_lg_u32 s55, 3
    s_cbranch_scc1 k3cs_80
    s_cmp_lg_u32 s56, 0
    s_cbranch_scc1 k3ch_81
    v_mfma_f32_16x16x32_bf16 v[180:183], v[208:211], v[124:127], v[180:183]
    v_mfma_f32_16x16x32_bf16 v[184:187], v[208:211], v[128:131], v[184:187]
    v_mfma_f32_16x16x32_bf16 v[188:191], v[208:211], v[132:135], v[188:191]
    v_mfma_f32_16x16x32_bf16 v[192:195], v[208:211], v[136:139], v[192:195]
    s_branch k3cs_80
k3ch_81:
    v_mfma_f32_16x16x32_bf16 v[180:183], v[208:211], v[140:143], v[180:183]
    v_mfma_f32_16x16x32_bf16 v[184:187], v[208:211], v[144:147], v[184:187]
    v_mfma_f32_16x16x32_bf16 v[188:191], v[208:211], v[148:151], v[188:191]
k3cs_80:
    s_nop 7
    s_barrier
    s_mul_i32 s15, s55, 448
    s_lshl_b32 s57, s56, 8
    s_add_u32 s15, s15, s57
    v_lshl_add_u32 v6, v2, 2, s15
    s_mov_b64 exec, 0xffff
    ds_write_b32 v6, v180 offset:0
    ds_write_b32 v6, v184 offset:64
    ds_write_b32 v6, v188 offset:128
    s_cmp_lg_u32 s56, 0
    s_cbranch_scc1 k3c4_82
    ds_write_b32 v6, v192 offset:192
k3c4_82:
    s_mov_b64 exec, -1
    s_waitcnt vmcnt(0)
    v_add_f32 v212, v212, v214
    v_add_f32 v213, v213, v215
    s_nop 1
    v_add_f32_dpp v214, v212, v212 quad_perm:[1,0,3,2] row_mask:0xf bank_mask:0xf
    v_add_f32_dpp v215, v213, v213 quad_perm:[1,0,3,2] row_mask:0xf bank_mask:0xf
    v_mov_b32 v212, v214
    v_mov_b32 v213, v215
    s_nop 1
    v_add_f32_dpp v214, v212, v212 quad_perm:[2,3,0,1] row_mask:0xf bank_mask:0xf
    v_add_f32_dpp v215, v213, v213 quad_perm:[2,3,0,1] row_mask:0xf bank_mask:0xf
    v_mov_b32 v212, v214
    v_mov_b32 v213, v215
    v_lshlrev_b32 v9, 4, v2
    ds_bpermute_b32 v214, v9, v212
    ds_bpermute_b32 v215, v9, v213
    s_waitcnt lgkmcnt(0)
    v_mov_b32 v212, v214
    v_mov_b32 v213, v215
    v_mul_f32 v212, 0x3acccccd, v212
    v_mul_f32 v213, 0x3acccccd, v213
    v_fma_f32 v213, -v212, v212, v213
    v_add_f32 v213, 0x3727c5ac, v213
    v_rsq_f32 v213, v213
    v_sub_f32 v212, 0, v212
    s_waitcnt lgkmcnt(0)
    s_barrier
    v_lshlrev_b32 v6, 2, v0
    v_cmp_gt_u32 vcc, 112, v0
    s_and_saveexec_b64 s[58:59], vcc
    ds_read_b32 v16, v6 offset:0
    ds_read_b32 v17, v6 offset:448
    ds_read_b32 v18, v6 offset:896
    ds_read_b32 v19, v6 offset:1344
    s_waitcnt lgkmcnt(0)
    v_add_f32 v16, v16, v17
    v_add_f32 v18, v18, v19
    v_add_f32 v16, v16, v18
    ds_write_b32 v6, v16 offset:2048
    s_mov_b64 exec, -1
    s_waitcnt lgkmcnt(0)
    s_barrier
    v_lshlrev_b32 v6, 4, v3
    ds_read_b128 v[16:19], v6 offset:2048
    ds_read_b128 v[32:35], v6 offset:2112
    ds_read_b128 v[48:51], v6 offset:2176
    ds_read_b128 v[64:67], v6 offset:2240
    ds_read_b128 v[80:83], v6 offset:2304
    ds_read_b128 v[96:99], v6 offset:2368
    ds_read_b128 v[112:115], v6 offset:2432
    s_mul_i32 s15, s46, 55296
    s_add_u32 s15, s15, 8388608
    s_add_u32 s16, s10, s15
    s_addc_u32 s17, s11, 0
    s_and_b32 s17, s17, 0xffff
    s_mov_b32 s18, 0xd800
    s_mov_b32 s19, 0x00020000
    s_lshl_b32 s58, s13, 9
    s_mov_b32 s45, 0xbfb8aa3b
    v_mul_f32 v214, s45, v213
    s_waitcnt lgkmcnt(0)
    v_fma_f32 v152, v212, v16, v152
    v_fma_f32 v153, v212, v17, v153
    v_fma_f32 v154, v212, v18, v154
    v_fma_f32 v155, v212, v19, v155
    v_fma_f32 v156, v212, v32, v156
    v_fma_f32 v157, v212, v33, v157
    v_fma_f32 v158, v212, v34, v158
    v_fma_f32 v159, v212, v35, v159
    v_fma_f32 v160, v212, v48, v160
    v_fma_f32 v161, v212, v49, v161
    v_fma_f32 v162, v212, v50, v162
    v_fma_f32 v163, v212, v51, v163
    v_fma_f32 v164, v212, v64, v164
    v_fma_f32 v165, v212, v65, v165
    v_fma_f32 v166, v212, v66, v166
    v_fma_f32 v167, v212, v67, v167
    v_fma_f32 v168, v212, v80, v168
    v_fma_f32 v169, v212, v81, v169
    v_fma_f32 v170, v212, v82, v170
    v_fma_f32 v171, v212, v83, v171
    v_fma_f32 v172, v212, v96, v172
    v_fma_f32 v173, v212, v97, v173
    v_fma_f32 v174, v212, v98, v174
    v_fma_f32 v175, v212, v99, v175
    v_fma_f32 v176, v212, v112, v176
    v_fma_f32 v177, v212, v113, v177
    v_fma_f32 v178, v212, v114, v178
    v_fma_f32 v179, v212, v115, v179
    v_mul_f32 v128, v152, v214
    v_mul_f32 v129, v153, v214
    v_mul_f32 v130, v154, v214
    v_mul_f32 v131, v155, v214
    v_mul_f32 v132, v156, v214
    v_mul_f32 v133, v157, v214
    v_mul_f32 v134, v158, v214
    v_mul_f32 v135, v159, v214
    v_mul_f32 v136, v160, v214
    v_mul_f32 v137, v161, v214
    v_mul_f32 v138, v162, v214
    v_mul_f32 v139, v163, v214
    v_mul_f32 v140, v164, v214
    v_mul_f32 v141, v165, v214
    v_mul_f32 v142, v166, v214
    v_mul_f32 v143, v167, v214
    v_mul_f32 v144, v168, v214
    v_mul_f32 v145, v169, v214
    v_mul_f32 v146, v170, v214
    v_mul_f32 v147, v171, v214
    v_mul_f32 v148, v172, v214
    v_mul_f32 v149, v173, v214
    v_mul_f32 v150, v174, v214
    v_mul_f32 v151, v175, v214
    v_mul_f32 v180, v176, v214
    v_mul_f32 v181, v177, v214
    v_mul_f32 v182, v178, v214
    v_mul_f32 v183, v179, v214
    v_exp_f32 v128, v128
    v_exp_f32 v129, v129
    v_exp_f32 v130, v130
    v_exp_f32 v131, v131
    v_exp_f32 v132, v132
    v_exp_f32 v133, v133
    v_exp_f32 v134, v134
    v_exp_f32 v135, v135
    v_exp_f32 v136, v136
    v_exp_f32 v137, v137
    v_exp_f32 v138, v138
    v_exp_f32 v139, v139
    v_exp_f32 v140, v140
    v_exp_f32 v141, v141
    v_exp_f32 v142, v142
    v_exp_f32 v143, v143
    v_exp_f32 v144, v144
    v_exp_f32 v145, v145
    v_exp_f32 v146, v146
    v_exp_f32 v147, v147
    v_exp_f32 v148, v148
    v_exp_f32 v149, v149
    v_exp_f32 v150, v150
    v_exp_f32 v151, v151
    v_exp_f32 v180, v180
    v_exp_f32 v181, v181
    v_exp_f32 v182, v182
    v_exp_f32 v183, v183
    v_mul_f32 v152, v152, v213
    v_mul_f32 v153, v153, v213
    v_mul_f32 v154, v154, v213
    v_mul_f32 v155, v155, v213
    v_mul_f32 v156, v156, v213
    v_mul_f32 v157, v157, v213
    v_mul_f32 v158, v158, v213
    v_mul_f32 v159, v159, v213
    v_mul_f32 v160, v160, v213
    v_mul_f32 v161, v161, v213
    v_mul_f32 v162, v162, v213
    v_mul_f32 v163, v163, v213
    v_mul_f32 v164, v164, v213
    v_mul_f32 v165, v165, v213
    v_mul_f32 v166, v166, v213
    v_mul_f32 v167, v167, v213
    v_mul_f32 v168, v168, v213
    v_mul_f32 v169, v169, v213
    v_mul_f32 v170, v170, v213
    v_mul_f32 v171, v171, v213
    v_mul_f32 v172, v172, v213
    v_mul_f32 v173, v173, v213
    v_mul_f32 v174, v174, v213
    v_mul_f32 v175, v175, v213
    v_mul_f32 v176, v176, v213
    v_mul_f32 v177, v177, v213
    v_mul_f32 v178, v178, v213
    v_mul_f32 v179, v179, v213
    v_add_f32 v128, 1.0, v128
    v_add_f32 v129, 1.0, v129
    v_add_f32 v130, 1.0, v130
    v_add_f32 v131, 1.0, v131
    v_add_f32 v132, 1.0, v132
    v_add_f32 v133, 1.0, v133
    v_add_f32 v134, 1.0, v134
    v_add_f32 v135, 1.0, v135
    v_add_f32 v136, 1.0, v136
    v_add_f32 v137, 1.0, v137
    v_add_f32 v138, 1.0, v138
    v_add_f32 v139, 1.0, v139
    v_add_f32 v140, 1.0, v140
    v_add_f32 v141, 1.0, v141
    v_add_f32 v142, 1.0, v142
    v_add_f32 v143, 1.0, v143
    v_add_f32 v144, 1.0, v144
    v_add_f32 v145, 1.0, v145
    v_add_f32 v146, 1.0, v146
    v_add_f32 v147, 1.0, v147
    v_add_f32 v148, 1.0, v148
    v_add_f32 v149, 1.0, v149
    v_add_f32 v150, 1.0, v150
    v_add_f32 v151, 1.0, v151
    v_add_f32 v180, 1.0, v180
    v_add_f32 v181, 1.0, v181
    v_add_f32 v182, 1.0, v182
    v_add_f32 v183, 1.0, v183
    v_rcp_f32 v128, v128
    v_rcp_f32 v129, v129
    v_rcp_f32 v130, v130
    v_rcp_f32 v131, v131
    v_rcp_f32 v132, v132
    v_rcp_f32 v133, v133
    v_rcp_f32 v134, v134
    v_rcp_f32 v135, v135
    v_rcp_f32 v136, v136
    v_rcp_f32 v137, v137
    v_rcp_f32 v138, v138
    v_rcp_f32 v139, v139
    v_rcp_f32 v140, v140
    v_rcp_f32 v141, v141
    v_rcp_f32 v142, v142
    v_rcp_f32 v143, v143
    v_rcp_f32 v144, v144
    v_rcp_f32 v145, v145
    v_rcp_f32 v146, v146
    v_rcp_f32 v147, v147
    v_rcp_f32 v148, v148
    v_rcp_f32 v149, v149
    v_rcp_f32 v150, v150
    v_rcp_f32 v151, v151
    v_rcp_f32 v180, v180
    v_rcp_f32 v181, v181
    v_rcp_f32 v182, v182
    v_rcp_f32 v183, v183
    v_mul_f32 v152, v152, v128
    v_mul_f32 v153, v153, v129
    v_mul_f32 v154, v154, v130
    v_mul_f32 v155, v155, v131
    v_mul_f32 v156, v156, v132
    v_mul_f32 v157, v157, v133
    v_mul_f32 v158, v158, v134
    v_mul_f32 v159, v159, v135
    v_mul_f32 v160, v160, v136
    v_mul_f32 v161, v161, v137
    v_mul_f32 v162, v162, v138
    v_mul_f32 v163, v163, v139
    v_mul_f32 v164, v164, v140
    v_mul_f32 v165, v165, v141
    v_mul_f32 v166, v166, v142
    v_mul_f32 v167, v167, v143
    v_mul_f32 v168, v168, v144
    v_mul_f32 v169, v169, v145
    v_mul_f32 v170, v170, v146
    v_mul_f32 v171, v171, v147
    v_mul_f32 v172, v172, v148
    v_mul_f32 v173, v173, v149
    v_mul_f32 v174, v174, v150
    v_mul_f32 v175, v175, v151
    v_mul_f32 v176, v176, v180
    v_mul_f32 v177, v177, v181
    v_mul_f32 v178, v178, v182
    v_mul_f32 v179, v179, v183
    v_cvt_pk_bf16_f32 v184, v152, v153
    v_cvt_pk_bf16_f32 v185, v154, v155
    v_cvt_pk_bf16_f32 v186, v156, v157
    v_cvt_pk_bf16_f32 v187, v158, v159
    v_cvt_pk_bf16_f32 v188, v160, v161
    v_cvt_pk_bf16_f32 v189, v162, v163
    v_cvt_pk_bf16_f32 v190, v164, v165
    v_cvt_pk_bf16_f32 v191, v166, v167
    v_cvt_pk_bf16_f32 v192, v168, v169
    v_cvt_pk_bf16_f32 v193, v170, v171
    v_cvt_pk_bf16_f32 v194, v172, v173
    v_cvt_pk_bf16_f32 v195, v174, v175
    v_cvt_pk_bf16_f32 v196, v176, v177
    v_cvt_pk_bf16_f32 v197, v178, v179
    s_lshr_b32 s59, s13, 1
    s_lshl_b32 s59, s59, 10
    v_add_u32 v6, 8, v4
    s_and_b32 s15, s13, 1
    s_cmp_eq_u32 s15, 1
    s_cbranch_scc1 k3odd_83
    buffer_store_dwordx4 v[184:187], v4, s[16:19], s59 offen offset:0
    buffer_store_dwordx4 v[188:191], v4, s[16:19], s59 offen offset:1024
    buffer_store_dwordx4 v[192:195], v4, s[16:19], s59 offen offset:2048
    buffer_store_dwordx2 v[196:197], v4, s[16:19], s59 offen offset:3072
    s_branch k3sd_84
k3odd_83:
    buffer_store_dwordx2 v[184:185], v6, s[16:19], s59 offen
    buffer_store_dwordx4 v[186:189], v4, s[16:19], s59 offen offset:1024
    buffer_store_dwordx4 v[190:193], v4, s[16:19], s59 offen offset:2048
    buffer_store_dwordx4 v[194:197], v4, s[16:19], s59 offen offset:3072
k3sd_84:
k3_kernel_end:
    s_endpgm
.globl k4_kernel
.p2align 8
.type k4_kernel,@function
k4_kernel:
    s_cmp_ge_u32 s2, 256
    s_cbranch_scc1 k4_kernel_end
    s_cmp_ge_u32 s2, 16
    s_cbranch_scc1 pcq_87
    s_getpc_b64 s[94:95]
pc_85:
    s_add_u32 s94, s94, (k4_kernel-pc_85)&0xffffffff
    s_addc_u32 s95, s95, ((k4_kernel-pc_85)>>32)&0xffffffff
    v_lshlrev_b32 v250, 7, v0
    s_mov_b32 s96, k4_kernel_end-k4_kernel
    v_cmp_gt_u32 vcc, s96, v250
    s_and_saveexec_b64 s[98:99], vcc
    s_cbranch_execz pcs_86
    global_load_dword v251, v250, s[94:95] offset:0
pcs_86:
    s_mov_b64 exec, s[98:99]
pcq_87:
    s_load_dwordx2 s[4:5], s[0:1], 48
    s_load_dwordx2 s[10:11], s[0:1], 64
    v_and_b32 v1, 63, v0
    v_lshrrev_b32 v4, 6, v0
    s_and_b32 s15, s2, 7
    s_lshr_b32 s13, s2, 3
    v_readfirstlane_b32 s14, v4
    s_lshr_b32 s12, s13, 2
    s_lshr_b32 s16, s15, 1
    s_lshl_b32 s16, s16, 3
    s_add_u32 s12, s12, s16
    s_and_b32 s13, s13, 3
    s_and_b32 s15, s15, 1
    s_lshl_b32 s15, s15, 2
    s_add_u32 s13, s13, s15
    v_and_b32 v2, 15, v1
    v_lshrrev_b32 v3, 4, v1
    v_lshlrev_b32 v4, 4, v1
    v_lshlrev_b32 v5, 3, v1
    s_mul_i32 s46, s14, 14
    s_cmp_eq_u32 s14, 3
    s_cselect_b32 s15, 1, 0
    s_sub_u32 s46, s46, s15
    s_cmp_ge_u32 s14, 2
    s_cselect_b32 s47, 13, 14
    s_waitcnt lgkmcnt(0)
    s_mul_i32 s15, s12, 221184
    s_lshl_b32 s44, s46, 10
    s_add_u32 s15, s15, s44
    s_add_u32 s15, s15, 8388608
    s_add_u32 s16, s10, s15
    s_addc_u32 s17, s11, 0
    s_and_b32 s17, s17, 0xffff
    s_mov_b32 s18, 0x36000
    s_mov_b32 s19, 0x00020000
    s_sub_u32 s18, s18, s44
    s_mul_i32 s15, s13, 54
    s_add_u32 s15, s15, s46
    s_mul_i32 s15, s15, 5120
    s_add_u32 s15, s15, 20971520
    s_add_u32 s20, s10, s15
    s_addc_u32 s21, s11, 0
    s_and_b32 s21, s21, 0xffff
    s_mov_b32 s22, 0x0
    s_mov_b32 s23, 0x00020000
    s_mul_i32 s22, s47, 5120
    s_mul_i32 s15, s12, 81920
    s_add_u32 s32, s4, s15
    s_addc_u32 s33, s5, 0
    s_and_b32 s33, s33, 0xffff
    s_mov_b32 s34, 0x14000
    s_mov_b32 s35, 0x00020000
    s_lshl_b32 s15, s14, 4
    v_add_u32 v10, s15, v2
    s_movk_i32 s15, 1280
    v_mul_lo_u32 v10, v10, s15
    s_mul_i32 s15, s13, 160
    v_lshl_add_u32 v10, v3, 3, v10
    v_add_u32 v10, s15, v10
    s_mov_b32 s60, 0
    s_mov_b32 s61, 55296
    s_mov_b32 s62, 110592
    s_mov_b32 s63, 165888
    s_mov_b32 s64, 0
    s_movk_i32 s65, 4096
    buffer_load_dwordx4 v[16:19], v4, s[16:19], s60 offen
    s_add_u32 s60, s60, 1024
    buffer_load_dwordx4 v[20:23], v4, s[16:19], s61 offen
    s_add_u32 s61, s61, 1024
    buffer_load_dwordx4 v[24:27], v4, s[16:19], s62 offen
    s_add_u32 s62, s62, 1024
    buffer_load_dwordx4 v[28:31], v4, s[16:19], s63 offen
    s_add_u32 s63, s63, 1024
    buffer_load_dwordx4 v[32:35], v4, s[20:23], s64 offen offset:0
    buffer_load_dwordx4 v[36:39], v4, s[20:23], s64 offen offset:1024
    buffer_load_dwordx4 v[40:43], v4, s[20:23], s64 offen offset:2048
    buffer_load_dwordx4 v[44:47], v4, s[20:23], s64 offen offset:3072
    s_add_u32 s64, s64, 5120
    buffer_load_dwordx4 v[48:51], v4, s[20:23], s65 offen
    s_add_u32 s65, s65, 5120
    buffer_load_dwordx4 v[52:55], v4, s[16:19], s60 offen
    s_add_u32 s60, s60, 1024
    buffer_load_dwordx4 v[56:59], v4, s[16:19], s61 offen
    s_add_u32 s61, s61, 1024
    buffer_load_dwordx4 v[60:63], v4, s[16:19], s62 offen
    s_add_u32 s62, s62, 1024
    buffer_load_dwordx4 v[64:67], v4, s[16:19], s63 offen
    s_add_u32 s63, s63, 1024
    buffer_load_dwordx4 v[68:71], v4, s[20:23], s64 offen offset:0
    buffer_load_dwordx4 v[72:75], v4, s[20:23], s64 offen offset:1024
    buffer_load_dwordx4 v[76:79], v4, s[20:23], s64 offen offset:2048
    buffer_load_dwordx4 v[80:83], v4, s[20:23], s64 offen offset:3072
    s_add_u32 s64, s64, 5120
    buffer_load_dwordx4 v[84:87], v4, s[20:23], s65 offen
    s_add_u32 s65, s65, 5120
    buffer_load_dwordx4 v[88:91], v4, s[16:19], s60 offen
    s_add_u32 s60, s60, 1024
    buffer_load_dwordx4 v[92:95], v4, s[16:19], s61 offen
    s_add_u32 s61, s61, 1024
    buffer_load_dwordx4 v[96:99], v4, s[16:19], s62 offen
    s_add_u32 s62, s62, 1024
    buffer_load_dwordx4 v[100:103], v4, s[16:19], s63 offen
    s_add_u32 s63, s63, 1024
    buffer_load_dwordx4 v[104:107], v4, s[20:23], s64 offen offset:0
    buffer_load_dwordx4 v[108:111], v4, s[20:23], s64 offen offset:1024
    buffer_load_dwordx4 v[112:115], v4, s[20:23], s64 offen offset:2048
    buffer_load_dwordx4 v[116:119], v4, s[20:23], s64 offen offset:3072
    s_add_u32 s64, s64, 5120
    buffer_load_dwordx4 v[120:123], v4, s[20:23], s65 offen
    s_add_u32 s65, s65, 5120
    buffer_load_dwordx4 a[80:83], v4, s[16:19], s60 offen
    s_add_u32 s60, s60, 1024
    buffer_load_dwordx4 a[84:87], v4, s[16:19], s61 offen
    s_add_u32 s61, s61, 1024
    buffer_load_dwordx4 a[88:91], v4, s[16:19], s62 offen
    s_add_u32 s62, s62, 1024
    buffer_load_dwordx4 a[92:95], v4, s[16:19], s63 offen
    s_add_u32 s63, s63, 1024
    buffer_load_dwordx4 a[96:99], v4, s[20:23], s64 offen offset:0
    buffer_load_dwordx4 a[100:103], v4, s[20:23], s64 offen offset:1024
    buffer_load_dwordx4 a[104:107], v4, s[20:23], s64 offen offset:2048
    buffer_load_dwordx4 a[108:111], v4, s[20:23], s64 offen offset:3072
    s_add_u32 s64, s64, 5120
    buffer_load_dwordx4 a[112:115], v4, s[20:23], s65 offen
    s_add_u32 s65, s65, 5120
    v_accvgpr_write_b32 a0, 0
    v_accvgpr_write_b32 a1, 0
    v_accvgpr_write_b32 a2, 0
    v_accvgpr_write_b32 a3, 0
    v_accvgpr_write_b32 a4, 0
    v_accvgpr_write_b32 a5, 0
    v_accvgpr_write_b32 a6, 0
    v_accvgpr_write_b32 a7, 0
    v_accvgpr_write_b32 a8, 0
    v_accvgpr_write_b32 a9, 0
    v_accvgpr_write_b32 a10, 0
    v_accvgpr_write_b32 a11, 0
    v_accvgpr_write_b32 a12, 0
    v_accvgpr_write_b32 a13, 0
    v_accvgpr_write_b32 a14, 0
    v_accvgpr_write_b32 a15, 0
    v_accvgpr_write_b32 a16, 0
    v_accvgpr_write_b32 a17, 0
    v_accvgpr_write_b32 a18, 0
    v_accvgpr_write_b32 a19, 0
    v_accvgpr_write_b32 a20, 0
    v_accvgpr_write_b32 a21, 0
    v_accvgpr_write_b32 a22, 0
    v_accvgpr_write_b32 a23, 0
    v_accvgpr_write_b32 a24, 0
    v_accvgpr_write_b32 a25, 0
    v_accvgpr_write_b32 a26, 0
    v_accvgpr_write_b32 a27, 0
    v_accvgpr_write_b32 a28, 0
    v_accvgpr_write_b32 a29, 0
    v_accvgpr_write_b32 a30, 0
    v_accvgpr_write_b32 a31, 0
    v_accvgpr_write_b32 a32, 0
    v_accvgpr_write_b32 a33, 0
    v_accvgpr_write_b32 a34, 0
    v_accvgpr_write_b32 a35, 0
    v_accvgpr_write_b32 a36, 0
    v_accvgpr_write_b32 a37, 0
    v_accvgpr_write_b32 a38, 0
    v_accvgpr_write_b32 a39, 0
    v_accvgpr_write_b32 a40, 0
    v_accvgpr_write_b32 a41, 0
    v_accvgpr_write_b32 a42, 0
    v_accvgpr_write_b32 a43, 0
    v_accvgpr_write_b32 a44, 0
    v_accvgpr_write_b32 a45, 0
    v_accvgpr_write_b32 a46, 0
    v_accvgpr_write_b32 a47, 0
    v_accvgpr_write_b32 a48, 0
    v_accvgpr_write_b32 a49, 0
    v_accvgpr_write_b32 a50, 0
    v_accvgpr_write_b32 a51, 0
    v_accvgpr_write_b32 a52, 0
    v_accvgpr_write_b32 a53, 0
    v_accvgpr_write_b32 a54, 0
    v_accvgpr_write_b32 a55, 0
    v_accvgpr_write_b32 a56, 0
    v_accvgpr_write_b32 a57, 0
    v_accvgpr_write_b32 a58, 0
    v_accvgpr_write_b32 a59, 0
    v_accvgpr_write_b32 a60, 0
    v_accvgpr_write_b32 a61, 0
    v_accvgpr_write_b32 a62, 0
    v_accvgpr_write_b32 a63, 0
    v_accvgpr_write_b32 a64, 0
    v_accvgpr_write_b32 a65, 0
    v_accvgpr_write_b32 a66, 0
    v_accvgpr_write_b32 a67, 0
    v_accvgpr_write_b32 a68, 0
    v_accvgpr_write_b32 a69, 0
    v_accvgpr_write_b32 a70, 0
    v_accvgpr_write_b32 a71, 0
    v_accvgpr_write_b32 a72, 0
    v_accvgpr_write_b32 a73, 0
    v_accvgpr_write_b32 a74, 0
    v_accvgpr_write_b32 a75, 0
    v_accvgpr_write_b32 a76, 0
    v_accvgpr_write_b32 a77, 0
    v_accvgpr_write_b32 a78, 0
    v_accvgpr_write_b32 a79, 0
    s_mov_b32 s66, 0
k4_kernel_loop:
    s_waitcnt vmcnt(27)
    v_mfma_f32_16x16x32_bf16 a[0:3], v[32:35], v[16:19], a[0:3]
    v_mfma_f32_16x16x32_bf16 a[20:23], v[32:35], v[20:23], a[20:23]
    buffer_load_dwordx4 a[116:119], v4, s[16:19], s60 offen
    s_add_u32 s60, s60, 1024
    v_mfma_f32_16x16x32_bf16 a[40:43], v[32:35], v[24:27], a[40:43]
    buffer_load_dwordx4 a[120:123], v4, s[16:19], s61 offen
    s_add_u32 s61, s61, 1024
    v_mfma_f32_16x16x32_bf16 a[60:63], v[32:35], v[28:31], a[60:63]
    buffer_load_dwordx4 a[124:127], v4, s[16:19], s62 offen
    s_add_u32 s62, s62, 1024
    v_mfma_f32_16x16x32_bf16 a[4:7], v[36:39], v[16:19], a[4:7]
    buffer_load_dwordx4 a[128:131], v4, s[16:19], s63 offen
    s_add_u32 s63, s63, 1024
    v_mfma_f32_16x16x32_bf16 a[24:27], v[36:39], v[20:23], a[24:27]
    buffer_load_dwordx4 a[132:135], v4, s[20:23], s64 offen offset:0
    v_mfma_f32_16x16x32_bf16 a[44:47], v[36:39], v[24:27], a[44:47]
    buffer_load_dwordx4 a[136:139], v4, s[20:23], s64 offen offset:1024
    v_mfma_f32_16x16x32_bf16 a[64:67], v[36:39], v[28:31], a[64:67]
    buffer_load_dwordx4 a[140:143], v4, s[20:23], s64 offen offset:2048
    v_mfma_f32_16x16x32_bf16 a[8:11], v[40:43], v[16:19], a[8:11]
    buffer_load_dwordx4 a[144:147], v4, s[20:23], s64 offen offset:3072
    s_add_u32 s64, s64, 5120
    v_mfma_f32_16x16x32_bf16 a[28:31], v[40:43], v[20:23], a[28:31]
    buffer_load_dwordx4 a[148:151], v4, s[20:23], s65 offen
    s_add_u32 s65, s65, 5120
    v_mfma_f32_16x16x32_bf16 a[48:51], v[40:43], v[24:27], a[48:51]
    v_mfma_f32_16x16x32_bf16 a[68:71], v[40:43], v[28:31], a[68:71]
    v_mfma_f32_16x16x32_bf16 a[12:15], v[44:47], v[16:19], a[12:15]
    v_mfma_f32_16x16x32_bf16 a[32:35], v[44:47], v[20:23], a[32:35]
    v_mfma_f32_16x16x32_bf16 a[52:55], v[44:47], v[24:27], a[52:55]
    v_mfma_f32_16x16x32_bf16 a[72:75], v[44:47], v[28:31], a[72:75]
    v_mfma_f32_16x16x32_bf16 a[16:19], v[48:51], v[16:19], a[16:19]
    v_mfma_f32_16x16x32_bf16 a[36:39], v[48:51], v[20:23], a[36:39]
    v_mfma_f32_16x16x32_bf16 a[56:59], v[48:51], v[24:27], a[56:59]
    v_mfma_f32_16x16x32_bf16 a[76:79], v[48:51], v[28:31], a[76:79]
    s_waitcnt vmcnt(27)
    v_mfma_f32_16x16x32_bf16 a[0:3], v[68:71], v[52:55], a[0:3]
    v_mfma_f32_16x16x32_bf16 a[20:23], v[68:71], v[56:59], a[20:23]
    buffer_load_dwordx4 a[152:155], v4, s[16:19], s60 offen
    s_add_u32 s60, s60, 1024
    v_mfma_f32_16x16x32_bf16 a[40:43], v[68:71], v[60:63], a[40:43]
    buffer_load_dwordx4 a[156:159], v4, s[16:19], s61 offen
    s_add_u32 s61, s61, 1024
    v_mfma_f32_16x16x32_bf16 a[60:63], v[68:71], v[64:67], a[60:63]
    buffer_load_dwordx4 a[160:163], v4, s[16:19], s62 offen
    s_add_u32 s62, s62, 1024
    v_mfma_f32_16x16x32_bf16 a[4:7], v[72:75], v[52:55], a[4:7]
    buffer_load_dwordx4 a[164:167], v4, s[16:19], s63 offen
    s_add_u32 s63, s63, 1024
    v_mfma_f32_16x16x32_bf16 a[24:27], v[72:75], v[56:59], a[24:27]
    buffer_load_dwordx4 a[168:171], v4, s[20:23], s64 offen offset:0
    v_mfma_f32_16x16x32_bf16 a[44:47], v[72:75], v[60:63], a[44:47]
    buffer_load_dwordx4 a[172:175], v4, s[20:23], s64 offen offset:1024
    v_mfma_f32_16x16x32_bf16 a[64:67], v[72:75], v[64:67], a[64:67]
    buffer_load_dwordx4 a[176:179], v4, s[20:23], s64 offen offset:2048
    v_mfma_f32_16x16x32_bf16 a[8:11], v[76:79], v[52:55], a[8:11]
    buffer_load_dwordx4 a[180:183], v4, s[20:23], s64 offen offset:3072
    s_add_u32 s64, s64, 5120
    v_mfma_f32_16x16x32_bf16 a[28:31], v[76:79], v[56:59], a[28:31]
    buffer_load_dwordx4 a[184:187], v4, s[20:23], s65 offen
    s_add_u32 s65, s65, 5120
    v_mfma_f32_16x16x32_bf16 a[48:51], v[76:79], v[60:63], a[48:51]
    v_mfma_f32_16x16x32_bf16 a[68:71], v[76:79], v[64:67], a[68:71]
    v_mfma_f32_16x16x32_bf16 a[12:15], v[80:83], v[52:55], a[12:15]
    v_mfma_f32_16x16x32_bf16 a[32:35], v[80:83], v[56:59], a[32:35]
    v_mfma_f32_16x16x32_bf16 a[52:55], v[80:83], v[60:63], a[52:55]
    v_mfma_f32_16x16x32_bf16 a[72:75], v[80:83], v[64:67], a[72:75]
    v_mfma_f32_16x16x32_bf16 a[16:19], v[84:87], v[52:55], a[16:19]
    v_mfma_f32_16x16x32_bf16 a[36:39], v[84:87], v[56:59], a[36:39]
    v_mfma_f32_16x16x32_bf16 a[56:59], v[84:87], v[60:63], a[56:59]
    v_mfma_f32_16x16x32_bf16 a[76:79], v[84:87], v[64:67], a[76:79]
    s_waitcnt vmcnt(27)
    v_mfma_f32_16x16x32_bf16 a[0:3], v[104:107], v[88:91], a[0:3]
    v_mfma_f32_16x16x32_bf16 a[20:23], v[104:107], v[92:95], a[20:23]
    buffer_load_dwordx4 a[188:191], v4, s[16:19], s60 offen
    s_add_u32 s60, s60, 1024
    v_mfma_f32_16x16x32_bf16 a[40:43], v[104:107], v[96:99], a[40:43]
    buffer_load_dwordx4 a[192:195], v4, s[16:19], s61 offen
    s_add_u32 s61, s61, 1024
    v_mfma_f32_16x16x32_bf16 a[60:63], v[104:107], v[100:103], a[60:63]
    buffer_load_dwordx4 a[196:199], v4, s[16:19], s62 offen
    s_add_u32 s62, s62, 1024
    v_mfma_f32_16x16x32_bf16 a[4:7], v[108:111], v[88:91], a[4:7]
    buffer_load_dwordx4 a[200:203], v4, s[16:19], s63 offen
    s_add_u32 s63, s63, 1024
    v_mfma_f32_16x16x32_bf16 a[24:27], v[108:111], v[92:95], a[24:27]
    buffer_load_dwordx4 a[204:207], v4, s[20:23], s64 offen offset:0
    v_mfma_f32_16x16x32_bf16 a[44:47], v[108:111], v[96:99], a[44:47]
    buffer_load_dwordx4 a[208:211], v4, s[20:23], s64 offen offset:1024
    v_mfma_f32_16x16x32_bf16 a[64:67], v[108:111], v[100:103], a[64:67]
    buffer_load_dwordx4 a[212:215], v4, s[20:23], s64 offen offset:2048
    v_mfma_f32_16x16x32_bf16 a[8:11], v[112:115], v[88:91], a[8:11]
    buffer_load_dwordx4 a[216:219], v4, s[20:23], s64 offen offset:3072
    s_add_u32 s64, s64, 5120
    v_mfma_f32_16x16x32_bf16 a[28:31], v[112:115], v[92:95], a[28:31]
    buffer_load_dwordx4 a[220:223], v4, s[20:23], s65 offen
    s_add_u32 s65, s65, 5120
    v_mfma_f32_16x16x32_bf16 a[48:51], v[112:115], v[96:99], a[48:51]
    v_mfma_f32_16x16x32_bf16 a[68:71], v[112:115], v[100:103], a[68:71]
    v_mfma_f32_16x16x32_bf16 a[12:15], v[116:119], v[88:91], a[12:15]
    v_mfma_f32_16x16x32_bf16 a[32:35], v[116:119], v[92:95], a[32:35]
    v_mfma_f32_16x16x32_bf16 a[52:55], v[116:119], v[96:99], a[52:55]
    v_mfma_f32_16x16x32_bf16 a[72:75], v[116:119], v[100:103], a[72:75]
    v_mfma_f32_16x16x32_bf16 a[16:19], v[120:123], v[88:91], a[16:19]
    v_mfma_f32_16x16x32_bf16 a[36:39], v[120:123], v[92:95], a[36:39]
    v_mfma_f32_16x16x32_bf16 a[56:59], v[120:123], v[96:99], a[56:59]
    v_mfma_f32_16x16x32_bf16 a[76:79], v[120:123], v[100:103], a[76:79]
    s_cmp_eq_u32 s66, 1
    s_cbranch_scc1 k4_kernel_tail
    s_waitcnt vmcnt(27)
    v_mfma_f32_16x16x32_bf16 a[0:3], a[96:99], a[80:83], a[0:3]
    v_mfma_f32_16x16x32_bf16 a[20:23], a[96:99], a[84:87], a[20:23]
    buffer_load_dwordx4 v[16:19], v4, s[16:19], s60 offen
    s_add_u32 s60, s60, 1024
    v_mfma_f32_16x16x32_bf16 a[40:43], a[96:99], a[88:91], a[40:43]
    buffer_load_dwordx4 v[20:23], v4, s[16:19], s61 offen
    s_add_u32 s61, s61, 1024
    v_mfma_f32_16x16x32_bf16 a[60:63], a[96:99], a[92:95], a[60:63]
    buffer_load_dwordx4 v[24:27], v4, s[16:19], s62 offen
    s_add_u32 s62, s62, 1024
    v_mfma_f32_16x16x32_bf16 a[4:7], a[100:103], a[80:83], a[4:7]
    buffer_load_dwordx4 v[28:31], v4, s[16:19], s63 offen
    s_add_u32 s63, s63, 1024
    v_mfma_f32_16x16x32_bf16 a[24:27], a[100:103], a[84:87], a[24:27]
    buffer_load_dwordx4 v[32:35], v4, s[20:23], s64 offen offset:0
    v_mfma_f32_16x16x32_bf16 a[44:47], a[100:103], a[88:91], a[44:47]
    buffer_load_dwordx4 v[36:39], v4, s[20:23], s64 offen offset:1024
    v_mfma_f32_16x16x32_bf16 a[64:67], a[100:103], a[92:95], a[64:67]
    buffer_load_dwordx4 v[40:43], v4, s[20:23], s64 offen offset:2048
    v_mfma_f32_16x16x32_bf16 a[8:11], a[104:107], a[80:83], a[8:11]
    buffer_load_dwordx4 v[44:47], v4, s[20:23], s64 offen offset:3072
    s_add_u32 s64, s64, 5120
    v_mfma_f32_16x16x32_bf16 a[28:31], a[104:107], a[84:87], a[28:31]
    buffer_load_dwordx4 v[48:51], v4, s[20:23], s65 offen
    s_add_u32 s65, s65, 5120
    v_mfma_f32_16x16x32_bf16 a[48:51], a[104:107], a[88:91], a[48:51]
    v_mfma_f32_16x16x32_bf16 a[68:71], a[104:107], a[92:95], a[68:71]
    v_mfma_f32_16x16x32_bf16 a[12:15], a[108:111], a[80:83], a[12:15]
    v_mfma_f32_16x16x32_bf16 a[32:35], a[108:111], a[84:87], a[32:35]
    v_mfma_f32_16x16x32_bf16 a[52:55], a[108:111], a[88:91], a[52:55]
    v_mfma_f32_16x16x32_bf16 a[72:75], a[108:111], a[92:95], a[72:75]
    v_mfma_f32_16x16x32_bf16 a[16:19], a[112:115], a[80:83], a[16:19]
    v_mfma_f32_16x16x32_bf16 a[36:39], a[112:115], a[84:87], a[36:39]
    v_mfma_f32_16x16x32_bf16 a[56:59], a[112:115], a[88:91], a[56:59]
    v_mfma_f32_16x16x32_bf16 a[76:79], a[112:115], a[92:95], a[76:79]
    s_waitcnt vmcnt(27)
    v_mfma_f32_16x16x32_bf16 a[0:3], a[132:135], a[116:119], a[0:3]
    v_mfma_f32_16x16x32_bf16 a[20:23], a[132:135], a[120:123], a[20:23]
    buffer_load_dwordx4 v[52:55], v4, s[16:19], s60 offen
    s_add_u32 s60, s60, 1024
    v_mfma_f32_16x16x32_bf16 a[40:43], a[132:135], a[124:127], a[40:43]
    buffer_load_dwordx4 v[56:59], v4, s[16:19], s61 offen
    s_add_u32 s61, s61, 1024
    v_mfma_f32_16x16x32_bf16 a[60:63], a[132:135], a[128:131], a[60:63]
    buffer_load_dwordx4 v[60:63], v4, s[16:19], s62 offen
    s_add_u32 s62, s62, 1024
    v_mfma_f32_16x16x32_bf16 a[4:7], a[136:139], a[116:119], a[4:7]
    buffer_load_dwordx4 v[64:67], v4, s[16:19], s63 offen
    s_add_u32 s63, s63, 1024
    v_mfma_f32_16x16x32_bf16 a[24:27], a[136:139], a[120:123], a[24:27]
    buffer_load_dwordx4 v[68:71], v4, s[20:23], s64 offen offset:0
    v_mfma_f32_16x16x32_bf16 a[44:47], a[136:139], a[124:127], a[44:47]
    buffer_load_dwordx4 v[72:75], v4, s[20:23], s64 offen offset:1024
    v_mfma_f32_16x16x32_bf16 a[64:67], a[136:139], a[128:131], a[64:67]
    buffer_load_dwordx4 v[76:79], v4, s[20:23], s64 offen offset:2048
    v_mfma_f32_16x16x32_bf16 a[8:11], a[140:143], a[116:119], a[8:11]
    buffer_load_dwordx4 v[80:83], v4, s[20:23], s64 offen offset:3072
    s_add_u32 s64, s64, 5120
    v_mfma_f32_16x16x32_bf16 a[28:31], a[140:143], a[120:123], a[28:31]
    buffer_load_dwordx4 v[84:87], v4, s[20:23], s65 offen
    s_add_u32 s65, s65, 5120
    v_mfma_f32_16x16x32_bf16 a[48:51], a[140:143], a[124:127], a[48:51]
    v_mfma_f32_16x16x32_bf16 a[68:71], a[140:143], a[128:131], a[68:71]
    v_mfma_f32_16x16x32_bf16 a[12:15], a[144:147], a[116:119], a[12:15]
    v_mfma_f32_16x16x32_bf16 a[32:35], a[144:147], a[120:123], a[32:35]
    v_mfma_f32_16x16x32_bf16 a[52:55], a[144:147], a[124:127], a[52:55]
    v_mfma_f32_16x16x32_bf16 a[72:75], a[144:147], a[128:131], a[72:75]
    v_mfma_f32_16x16x32_bf16 a[16:19], a[148:151], a[116:119], a[16:19]
    v_mfma_f32_16x16x32_bf16 a[36:39], a[148:151], a[120:123], a[36:39]
    v_mfma_f32_16x16x32_bf16 a[56:59], a[148:151], a[124:127], a[56:59]
    v_mfma_f32_16x16x32_bf16 a[76:79], a[148:151], a[128:131], a[76:79]
    s_waitcnt vmcnt(27)
    v_mfma_f32_16x16x32_bf16 a[0:3], a[168:171], a[152:155], a[0:3]
    v_mfma_f32_16x16x32_bf16 a[20:23], a[168:171], a[156:159], a[20:23]
    buffer_load_dwordx4 v[88:91], v4, s[16:19], s60 offen
    s_add_u32 s60, s60, 1024
    v_mfma_f32_16x16x32_bf16 a[40:43], a[168:171], a[160:163], a[40:43]
    buffer_load_dwordx4 v[92:95], v4, s[16:19], s61 offen
    s_add_u32 s61, s61, 1024
    v_mfma_f32_16x16x32_bf16 a[60:63], a[168:171], a[164:167], a[60:63]
    buffer_load_dwordx4 v[96:99], v4, s[16:19], s62 offen
    s_add_u32 s62, s62, 1024
    v_mfma_f32_16x16x32_bf16 a[4:7], a[172:175], a[152:155], a[4:7]
    buffer_load_dwordx4 v[100:103], v4, s[16:19], s63 offen
    s_add_u32 s63, s63, 1024
    v_mfma_f32_16x16x32_bf16 a[24:27], a[172:175], a[156:159], a[24:27]
    buffer_load_dwordx4 v[104:107], v4, s[20:23], s64 offen offset:0
    v_mfma_f32_16x16x32_bf16 a[44:47], a[172:175], a[160:163], a[44:47]
    buffer_load_dwordx4 v[108:111], v4, s[20:23], s64 offen offset:1024
    v_mfma_f32_16x16x32_bf16 a[64:67], a[172:175], a[164:167], a[64:67]
    buffer_load_dwordx4 v[112:115], v4, s[20:23], s64 offen offset:2048
    v_mfma_f32_16x16x32_bf16 a[8:11], a[176:179], a[152:155], a[8:11]
    buffer_load_dwordx4 v[116:119], v4, s[20:23], s64 offen offset:3072
    s_add_u32 s64, s64, 5120
    v_mfma_f32_16x16x32_bf16 a[28:31], a[176:179], a[156:159], a[28:31]
    buffer_load_dwordx4 v[120:123], v4, s[20:23], s65 offen
    s_add_u32 s65, s65, 5120
    v_mfma_f32_16x16x32_bf16 a[48:51], a[176:179], a[160:163], a[48:51]
    v_mfma_f32_16x16x32_bf16 a[68:71], a[176:179], a[164:167], a[68:71]
    v_mfma_f32_16x16x32_bf16 a[12:15], a[180:183], a[152:155], a[12:15]
    v_mfma_f32_16x16x32_bf16 a[32:35], a[180:183], a[156:159], a[32:35]
    v_mfma_f32_16x16x32_bf16 a[52:55], a[180:183], a[160:163], a[52:55]
    v_mfma_f32_16x16x32_bf16 a[72:75], a[180:183], a[164:167], a[72:75]
    v_mfma_f32_16x16x32_bf16 a[16:19], a[184:187], a[152:155], a[16:19]
    v_mfma_f32_16x16x32_bf16 a[36:39], a[184:187], a[156:159], a[36:39]
    v_mfma_f32_16x16x32_bf16 a[56:59], a[184:187], a[160:163], a[56:59]
    v_mfma_f32_16x16x32_bf16 a[76:79], a[184:187], a[164:167], a[76:79]
    s_waitcnt vmcnt(27)
    v_mfma_f32_16x16x32_bf16 a[0:3], a[204:207], a[188:191], a[0:3]
    v_mfma_f32_16x16x32_bf16 a[20:23], a[204:207], a[192:195], a[20:23]
    buffer_load_dwordx4 a[80:83], v4, s[16:19], s60 offen
    s_add_u32 s60, s60, 1024
    v_mfma_f32_16x16x32_bf16 a[40:43], a[204:207], a[196:199], a[40:43]
    buffer_load_dwordx4 a[84:87], v4, s[16:19], s61 offen
    s_add_u32 s61, s61, 1024
    v_mfma_f32_16x16x32_bf16 a[60:63], a[204:207], a[200:203], a[60:63]
    buffer_load_dwordx4 a[88:91], v4, s[16:19], s62 offen
    s_add_u32 s62, s62, 1024
    v_mfma_f32_16x16x32_bf16 a[4:7], a[208:211], a[188:191], a[4:7]
    buffer_load_dwordx4 a[92:95], v4, s[16:19], s63 offen
    s_add_u32 s63, s63, 1024
    v_mfma_f32_16x16x32_bf16 a[24:27], a[208:211], a[192:195], a[24:27]
    buffer_load_dwordx4 a[96:99], v4, s[20:23], s64 offen offset:0
    v_mfma_f32_16x16x32_bf16 a[44:47], a[208:211], a[196:199], a[44:47]
    buffer_load_dwordx4 a[100:103], v4, s[20:23], s64 offen offset:1024
    v_mfma_f32_16x16x32_bf16 a[64:67], a[208:211], a[200:203], a[64:67]
    buffer_load_dwordx4 a[104:107], v4, s[20:23], s64 offen offset:2048
    v_mfma_f32_16x16x32_bf16 a[8:11], a[212:215], a[188:191], a[8:11]
    buffer_load_dwordx4 a[108:111], v4, s[20:23], s64 offen offset:3072
    s_add_u32 s64, s64, 5120
    v_mfma_f32_16x16x32_bf16 a[28:31], a[212:215], a[192:195], a[28:31]
    buffer_load_dwordx4 a[112:115], v4, s[20:23], s65 offen
    s_add_u32 s65, s65, 5120
    v_mfma_f32_16x16x32_bf16 a[48:51], a[212:215], a[196:199], a[48:51]
    v_mfma_f32_16x16x32_bf16 a[68:71], a[212:215], a[200:203], a[68:71]
    v_mfma_f32_16x16x32_bf16 a[12:15], a[216:219], a[188:191], a[12:15]
    v_mfma_f32_16x16x32_bf16 a[32:35], a[216:219], a[192:195], a[32:35]
    v_mfma_f32_16x16x32_bf16 a[52:55], a[216:219], a[196:199], a[52:55]
    v_mfma_f32_16x16x32_bf16 a[72:75], a[216:219], a[200:203], a[72:75]
    v_mfma_f32_16x16x32_bf16 a[16:19], a[220:223], a[188:191], a[16:19]
    v_mfma_f32_16x16x32_bf16 a[36:39], a[220:223], a[192:195], a[36:39]
    v_mfma_f32_16x16x32_bf16 a[56:59], a[220:223], a[196:199], a[56:59]
    v_mfma_f32_16x16x32_bf16 a[76:79], a[220:223], a[200:203], a[76:79]
    s_add_u32 s66, s66, 1
    s_branch k4_kernel_loop
k4_kernel_tail:
    s_waitcnt vmcnt(27)
    v_mfma_f32_16x16x32_bf16 a[0:3], a[96:99], a[80:83], a[0:3]
    v_mfma_f32_16x16x32_bf16 a[20:23], a[96:99], a[84:87], a[20:23]
    v_mfma_f32_16x16x32_bf16 a[40:43], a[96:99], a[88:91], a[40:43]
    v_mfma_f32_16x16x32_bf16 a[60:63], a[96:99], a[92:95], a[60:63]
    v_mfma_f32_16x16x32_bf16 a[4:7], a[100:103], a[80:83], a[4:7]
    v_mfma_f32_16x16x32_bf16 a[24:27], a[100:103], a[84:87], a[24:27]
    v_mfma_f32_16x16x32_bf16 a[44:47], a[100:103], a[88:91], a[44:47]
    v_mfma_f32_16x16x32_bf16 a[64:67], a[100:103], a[92:95], a[64:67]
    v_mfma_f32_16x16x32_bf16 a[8:11], a[104:107], a[80:83], a[8:11]
    v_mfma_f32_16x16x32_bf16 a[28:31], a[104:107], a[84:87], a[28:31]
    v_mfma_f32_16x16x32_bf16 a[48:51], a[104:107], a[88:91], a[48:51]
    v_mfma_f32_16x16x32_bf16 a[68:71], a[104:107], a[92:95], a[68:71]
    v_mfma_f32_16x16x32_bf16 a[12:15], a[108:111], a[80:83], a[12:15]
    v_mfma_f32_16x16x32_bf16 a[32:35], a[108:111], a[84:87], a[32:35]
    v_mfma_f32_16x16x32_bf16 a[52:55], a[108:111], a[88:91], a[52:55]
    v_mfma_f32_16x16x32_bf16 a[72:75], a[108:111], a[92:95], a[72:75]
    v_mfma_f32_16x16x32_bf16 a[16:19], a[112:115], a[80:83], a[16:19]
    v_mfma_f32_16x16x32_bf16 a[36:39], a[112:115], a[84:87], a[36:39]
    v_mfma_f32_16x16x32_bf16 a[56:59], a[112:115], a[88:91], a[56:59]
    v_mfma_f32_16x16x32_bf16 a[76:79], a[112:115], a[92:95], a[76:79]
    s_waitcnt vmcnt(18)
    v_mfma_f32_16x16x32_bf16 a[0:3], a[132:135], a[116:119], a[0:3]
    v_mfma_f32_16x16x32_bf16 a[20:23], a[132:135], a[120:123], a[20:23]
    v_mfma_f32_16x16x32_bf16 a[40:43], a[132:135], a[124:127], a[40:43]
    v_mfma_f32_16x16x32_bf16 a[60:63], a[132:135], a[128:131], a[60:63]
    v_mfma_f32_16x16x32_bf16 a[4:7], a[136:139], a[116:119], a[4:7]
    v_mfma_f32_16x16x32_bf16 a[24:27], a[136:139], a[120:123], a[24:27]
    v_mfma_f32_16x16x32_bf16 a[44:47], a[136:139], a[124:127], a[44:47]
    v_mfma_f32_16x16x32_bf16 a[64:67], a[136:139], a[128:131], a[64:67]
    v_mfma_f32_16x16x32_bf16 a[8:11], a[140:143], a[116:119], a[8:11]
    v_mfma_f32_16x16x32_bf16 a[28:31], a[140:143], a[120:123], a[28:31]
    v_mfma_f32_16x16x32_bf16 a[48:51], a[140:143], a[124:127], a[48:51]
    v_mfma_f32_16x16x32_bf16 a[68:71], a[140:143], a[128:131], a[68:71]
    v_mfma_f32_16x16x32_bf16 a[12:15], a[144:147], a[116:119], a[12:15]
    v_mfma_f32_16x16x32_bf16 a[32:35], a[144:147], a[120:123], a[32:35]
    v_mfma_f32_16x16x32_bf16 a[52:55], a[144:147], a[124:127], a[52:55]
    v_mfma_f32_16x16x32_bf16 a[72:75], a[144:147], a[128:131], a[72:75]
    v_mfma_f32_16x16x32_bf16 a[16:19], a[148:151], a[116:119], a[16:19]
    v_mfma_f32_16x16x32_bf16 a[36:39], a[148:151], a[120:123], a[36:39]
    v_mfma_f32_16x16x32_bf16 a[56:59], a[148:151], a[124:127], a[56:59]
    v_mfma_f32_16x16x32_bf16 a[76:79], a[148:151], a[128:131], a[76:79]
    s_waitcnt vmcnt(9)
    v_mfma_f32_16x16x32_bf16 a[0:3], a[168:171], a[152:155], a[0:3]
    v_mfma_f32_16x16x32_bf16 a[20:23], a[168:171], a[156:159], a[20:23]
    v_mfma_f32_16x16x32_bf16 a[40:43], a[168:171], a[160:163], a[40:43]
    v_mfma_f32_16x16x32_bf16 a[60:63], a[168:171], a[164:167], a[60:63]
    v_mfma_f32_16x16x32_bf16 a[4:7], a[172:175], a[152:155], a[4:7]
    v_mfma_f32_16x16x32_bf16 a[24:27], a[172:175], a[156:159], a[24:27]
    v_mfma_f32_16x16x32_bf16 a[44:47], a[172:175], a[160:163], a[44:47]
    v_mfma_f32_16x16x32_bf16 a[64:67], a[172:175], a[164:167], a[64:67]
    v_mfma_f32_16x16x32_bf16 a[8:11], a[176:179], a[152:155], a[8:11]
    v_mfma_f32_16x16x32_bf16 a[28:31], a[176:179], a[156:159], a[28:31]
    v_mfma_f32_16x16x32_bf16 a[48:51], a[176:179], a[160:163], a[48:51]
    v_mfma_f32_16x16x32_bf16 a[68:71], a[176:179], a[164:167], a[68:71]
    v_mfma_f32_16x16x32_bf16 a[12:15], a[180:183], a[152:155], a[12:15]
    v_mfma_f32_16x16x32_bf16 a[32:35], a[180:183], a[156:159], a[32:35]
    v_mfma_f32_16x16x32_bf16 a[52:55], a[180:183], a[160:163], a[52:55]
    v_mfma_f32_16x16x32_bf16 a[72:75], a[180:183], a[164:167], a[72:75]
    v_mfma_f32_16x16x32_bf16 a[16:19], a[184:187], a[152:155], a[16:19]
    v_mfma_f32_16x16x32_bf16 a[36:39], a[184:187], a[156:159], a[36:39]
    v_mfma_f32_16x16x32_bf16 a[56:59], a[184:187], a[160:163], a[56:59]
    v_mfma_f32_16x16x32_bf16 a[76:79], a[184:187], a[164:167], a[76:79]
    s_waitcnt vmcnt(0)
    v_mfma_f32_16x16x32_bf16 a[0:3], a[204:207], a[188:191], a[0:3]
    v_mfma_f32_16x16x32_bf16 a[20:23], a[204:207], a[192:195], a[20:23]
    v_mfma_f32_16x16x32_bf16 a[40:43], a[204:207], a[196:199], a[40:43]
    v_mfma_f32_16x16x32_bf16 a[60:63], a[204:207], a[200:203], a[60:63]
    v_mfma_f32_16x16x32_bf16 a[4:7], a[208:211], a[188:191], a[4:7]
    v_mfma_f32_16x16x32_bf16 a[24:27], a[208:211], a[192:195], a[24:27]
    v_mfma_f32_16x16x32_bf16 a[44:47], a[208:211], a[196:199], a[44:47]
    v_mfma_f32_16x16x32_bf16 a[64:67], a[208:211], a[200:203], a[64:67]
    v_mfma_f32_16x16x32_bf16 a[8:11], a[212:215], a[188:191], a[8:11]
    v_mfma_f32_16x16x32_bf16 a[28:31], a[212:215], a[192:195], a[28:31]
    v_mfma_f32_16x16x32_bf16 a[48:51], a[212:215], a[196:199], a[48:51]
    v_mfma_f32_16x16x32_bf16 a[68:71], a[212:215], a[200:203], a[68:71]
    v_mfma_f32_16x16x32_bf16 a[12:15], a[216:219], a[188:191], a[12:15]
    v_mfma_f32_16x16x32_bf16 a[32:35], a[216:219], a[192:195], a[32:35]
    v_mfma_f32_16x16x32_bf16 a[52:55], a[216:219], a[196:199], a[52:55]
    v_mfma_f32_16x16x32_bf16 a[72:75], a[216:219], a[200:203], a[72:75]
    v_mfma_f32_16x16x32_bf16 a[16:19], a[220:223], a[188:191], a[16:19]
    v_mfma_f32_16x16x32_bf16 a[36:39], a[220:223], a[192:195], a[36:39]
    v_mfma_f32_16x16x32_bf16 a[56:59], a[220:223], a[196:199], a[56:59]
    v_mfma_f32_16x16x32_bf16 a[76:79], a[220:223], a[200:203], a[76:79]
k4_kernel_skip:
    s_waitcnt vmcnt(0)
    s_lshl_b32 s15, s12, 2
    s_add_u32 s15, s15, s14
    s_mul_i32 s15, s15, 20480
    s_add_u32 s15, s15, 4194304
    s_add_u32 s36, s10, s15
    s_addc_u32 s37, s11, 0
    s_and_b32 s37, s37, 0xffff
    s_mov_b32 s38, 0x5000
    s_mov_b32 s39, 0x00020000
    s_mul_i32 s44, s13, 5
    s_add_u32 s15, s44, 0
    s_lshr_b32 s45, s15, 1
    s_lshl_b32 s45, s45, 10
    s_and_b32 s15, s15, 1
    s_lshl_b32 s15, s15, 3
    s_add_u32 s48, s15, s45
    s_add_u32 s15, s44, 1
    s_lshr_b32 s45, s15, 1
    s_lshl_b32 s45, s45, 10
    s_and_b32 s15, s15, 1
    s_lshl_b32 s15, s15, 3
    s_add_u32 s49, s15, s45
    s_add_u32 s15, s44, 2
    s_lshr_b32 s45, s15, 1
    s_lshl_b32 s45, s45, 10
    s_and_b32 s15, s15, 1
    s_lshl_b32 s15, s15, 3
    s_add_u32 s50, s15, s45
    s_add_u32 s15, s44, 3
    s_lshr_b32 s45, s15, 1
    s_lshl_b32 s45, s45, 10
    s_and_b32 s15, s15, 1
    s_lshl_b32 s15, s15, 3
    s_add_u32 s51, s15, s45
    s_add_u32 s15, s44, 4
    s_lshr_b32 s45, s15, 1
    s_lshl_b32 s45, s45, 10
    s_and_b32 s15, s15, 1
    s_lshl_b32 s15, s15, 3
    s_add_u32 s52, s15, s45
    v_lshlrev_b32 v5, 4, v1
    buffer_load_dwordx2 v[200:201], v5, s[36:39], s48 offen
    buffer_load_dwordx2 v[202:203], v5, s[36:39], s49 offen
    buffer_load_dwordx2 v[204:205], v5, s[36:39], s50 offen
    buffer_load_dwordx2 v[206:207], v5, s[36:39], s51 offen
    buffer_load_dwordx2 v[208:209], v5, s[36:39], s52 offen
    s_mul_i32 s15, s14, 20480
    v_lshlrev_b32 v4, 4, v1
    v_add_u32 v6, s15, v4
    s_nop 7
    ds_write_b128 v6, a[0:3] offset:0
    ds_write_b128 v6, a[4:7] offset:1024
    ds_write_b128 v6, a[8:11] offset:2048
    ds_write_b128 v6, a[12:15] offset:3072
    ds_write_b128 v6, a[16:19] offset:4096
    ds_write_b128 v6, a[20:23] offset:5120
    ds_write_b128 v6, a[24:27] offset:6144
    ds_write_b128 v6, a[28:31] offset:7168
    ds_write_b128 v6, a[32:35] offset:8192
    ds_write_b128 v6, a[36:39] offset:9216
    ds_write_b128 v6, a[40:43] offset:10240
    ds_write_b128 v6, a[44:47] offset:11264
    ds_write_b128 v6, a[48:51] offset:12288
    ds_write_b128 v6, a[52:55] offset:13312
    ds_write_b128 v6, a[56:59] offset:14336
    ds_write_b128 v6, a[60:63] offset:15360
    ds_write_b128 v6, a[64:67] offset:16384
    ds_write_b128 v6, a[68:71] offset:17408
    ds_write_b128 v6, a[72:75] offset:18432
    ds_write_b128 v6, a[76:79] offset:19456
    s_waitcnt lgkmcnt(0)
    s_barrier
    s_mul_i32 s15, s14, 5120
    v_add_u32 v6, s15, v4
    v_add_u32 v7, 40960, v6
    ds_read_b128 v[16:19], v6 offset:0
    ds_read_b128 v[20:23], v6 offset:1024
    ds_read_b128 v[24:27], v6 offset:2048
    ds_read_b128 v[28:31], v6 offset:3072
    ds_read_b128 v[32:35], v6 offset:4096
    ds_read_b128 v[36:39], v6 offset:20480
    ds_read_b128 v[40:43], v6 offset:21504
    ds_read_b128 v[44:47], v6 offset:22528
    ds_read_b128 v[48:51], v6 offset:23552
    ds_read_b128 v[52:55], v6 offset:24576
    ds_read_b128 v[56:59], v7 offset:0
    ds_read_b128 v[60:63], v7 offset:1024
    ds_read_b128 v[64:67], v7 offset:2048
    ds_read_b128 v[68:71], v7 offset:3072
    ds_read_b128 v[72:75], v7 offset:4096
    ds_read_b128 v[76:79], v7 offset:20480
    ds_read_b128 v[80:83], v7 offset:21504
    ds_read_b128 v[84:87], v7 offset:22528
    ds_read_b128 v[88:91], v7 offset:23552
    ds_read_b128 v[92:95], v7 offset:24576
    s_waitcnt lgkmcnt(0) vmcnt(0)
    v_add_f32 v16, v16, v36
    v_add_f32 v56, v56, v76
    v_add_f32 v16, v16, v56
    v_add_f32 v17, v17, v37
    v_add_f32 v57, v57, v77
    v_add_f32 v17, v17, v57
    v_add_f32 v18, v18, v38
    v_add_f32 v58, v58, v78
    v_add_f32 v18, v18, v58
    v_add_f32 v19, v19, v39
    v_add_f32 v59, v59, v79
    v_add_f32 v19, v19, v59
    v_add_f32 v20, v20, v40
    v_add_f32 v60, v60, v80
    v_add_f32 v20, v20, v60
    v_add_f32 v21, v21, v41
    v_add_f32 v61, v61, v81
    v_add_f32 v21, v21, v61
    v_add_f32 v22, v22, v42
    v_add_f32 v62, v62, v82
    v_add_f32 v22, v22, v62
    v_add_f32 v23, v23, v43
    v_add_f32 v63, v63, v83
    v_add_f32 v23, v23, v63
    v_add_f32 v24, v24, v44
    v_add_f32 v64, v64, v84
    v_add_f32 v24, v24, v64
    v_add_f32 v25, v25, v45
    v_add_f32 v65, v65, v85
    v_add_f32 v25, v25, v65
    v_add_f32 v26, v26, v46
    v_add_f32 v66, v66, v86
    v_add_f32 v26, v26, v66
    v_add_f32 v27, v27, v47
    v_add_f32 v67, v67, v87
    v_add_f32 v27, v27, v67
    v_add_f32 v28, v28, v48
    v_add_f32 v68, v68, v88
    v_add_f32 v28, v28, v68
    v_add_f32 v29, v29, v49
    v_add_f32 v69, v69, v89
    v_add_f32 v29, v29, v69
    v_add_f32 v30, v30, v50
    v_add_f32 v70, v70, v90
    v_add_f32 v30, v30, v70
    v_add_f32 v31, v31, v51
    v_add_f32 v71, v71, v91
    v_add_f32 v31, v31, v71
    v_add_f32 v32, v32, v52
    v_add_f32 v72, v72, v92
    v_add_f32 v32, v32, v72
    v_add_f32 v33, v33, v53
    v_add_f32 v73, v73, v93
    v_add_f32 v33, v33, v73
    v_add_f32 v34, v34, v54
    v_add_f32 v74, v74, v94
    v_add_f32 v34, v34, v74
    v_add_f32 v35, v35, v55
    v_add_f32 v75, v75, v95
    v_add_f32 v35, v35, v75
    v_lshlrev_b32 v100, 16, v200
    v_and_b32 v101, 0xffff0000, v200
    v_add_f32 v16, v16, v100
    v_add_f32 v17, v17, v101
    v_lshlrev_b32 v100, 16, v201
    v_and_b32 v101, 0xffff0000, v201
    v_add_f32 v18, v18, v100
    v_add_f32 v19, v19, v101
    v_lshlrev_b32 v100, 16, v202
    v_and_b32 v101, 0xffff0000, v202
    v_add_f32 v20, v20, v100
    v_add_f32 v21, v21, v101
    v_lshlrev_b32 v100, 16, v203
    v_and_b32 v101, 0xffff0000, v203
    v_add_f32 v22, v22, v100
    v_add_f32 v23, v23, v101
    v_lshlrev_b32 v100, 16, v204
    v_and_b32 v101, 0xffff0000, v204
    v_add_f32 v24, v24, v100
    v_add_f32 v25, v25, v101
    v_lshlrev_b32 v100, 16, v205
    v_and_b32 v101, 0xffff0000, v205
    v_add_f32 v26, v26, v100
    v_add_f32 v27, v27, v101
    v_lshlrev_b32 v100, 16, v206
    v_and_b32 v101, 0xffff0000, v206
    v_add_f32 v28, v28, v100
    v_add_f32 v29, v29, v101
    v_lshlrev_b32 v100, 16, v207
    v_and_b32 v101, 0xffff0000, v207
    v_add_f32 v30, v30, v100
    v_add_f32 v31, v31, v101
    v_lshlrev_b32 v100, 16, v208
    v_and_b32 v101, 0xffff0000, v208
    v_add_f32 v32, v32, v100
    v_add_f32 v33, v33, v101
    v_lshlrev_b32 v100, 16, v209
    v_and_b32 v101, 0xffff0000, v209
    v_add_f32 v34, v34, v100
    v_add_f32 v35, v35, v101
    v_cvt_pk_bf16_f32 v110, v16, v17
    v_cvt_pk_bf16_f32 v111, v18, v19
    v_cvt_pk_bf16_f32 v112, v20, v21
    v_cvt_pk_bf16_f32 v113, v22, v23
    v_cvt_pk_bf16_f32 v114, v24, v25
    v_cvt_pk_bf16_f32 v115, v26, v27
    v_cvt_pk_bf16_f32 v116, v28, v29
    v_cvt_pk_bf16_f32 v117, v30, v31
    v_cvt_pk_bf16_f32 v118, v32, v33
    v_cvt_pk_bf16_f32 v119, v34, v35
    buffer_store_dwordx2 v[110:111], v10, s[32:35], 0 offen offset:0
    buffer_store_dwordx2 v[112:113], v10, s[32:35], 0 offen offset:32
    buffer_store_dwordx2 v[114:115], v10, s[32:35], 0 offen offset:64
    buffer_store_dwordx2 v[116:117], v10, s[32:35], 0 offen offset:96
    buffer_store_dwordx2 v[118:119], v10, s[32:35], 0 offen offset:128
k4_kernel_end:
    s_endpgm
.section .rodata,"a"
.p2align 6
.amdhsa_kernel k1_kernel
  .amdhsa_next_free_vgpr 256
  .amdhsa_next_free_sgpr 102
  .amdhsa_accum_offset 256
  .amdhsa_group_segment_fixed_size 0
  .amdhsa_kernarg_size 72
  .amdhsa_user_sgpr_count 2
  .amdhsa_user_sgpr_kernarg_segment_ptr 1
  .amdhsa_system_sgpr_workgroup_id_x 1
.end_amdhsa_kernel
.p2align 6
.amdhsa_kernel k2_kernel
  .amdhsa_next_free_vgpr 512
  .amdhsa_next_free_sgpr 102
  .amdhsa_accum_offset 256
  .amdhsa_group_segment_fixed_size 0
  .amdhsa_kernarg_size 72
  .amdhsa_user_sgpr_count 2
  .amdhsa_user_sgpr_kernarg_segment_ptr 1
  .amdhsa_system_sgpr_workgroup_id_x 1
.end_amdhsa_kernel
.p2align 6
.amdhsa_kernel k3_kernel
  .amdhsa_next_free_vgpr 256
  .amdhsa_next_free_sgpr 102
  .amdhsa_accum_offset 256
  .amdhsa_group_segment_fixed_size 0
  .amdhsa_kernarg_size 72
  .amdhsa_user_sgpr_count 2
  .amdhsa_user_sgpr_kernarg_segment_ptr 1
  .amdhsa_system_sgpr_workgroup_id_x 1
.end_amdhsa_kernel
.p2align 6
.amdhsa_kernel k4_kernel
  .amdhsa_next_free_vgpr 512
  .amdhsa_next_free_sgpr 102
  .amdhsa_accum_offset 256
  .amdhsa_group_segment_fixed_size 0
  .amdhsa_kernarg_size 72
  .amdhsa_user_sgpr_count 2
  .amdhsa_user_sgpr_kernarg_segment_ptr 1
  .amdhsa_system_sgpr_workgroup_id_x 1
.end_amdhsa_kernel
```
